```python
import torch

def _softmax(x, axis=-1):
    return torch.softmax(x, dim=axis)
def _gelu(x):
    return torch.nn.functional.gelu(x, approximate="tanh")
def _silu(x):
    return torch.nn.functional.silu(x)
def _sigmoid(x):
    return torch.sigmoid(x)
def _layernorm(x, axis=-1, eps=1e-5):
    m = x.mean(dim=axis, keepdim=True)
    v = x.var(dim=axis, keepdim=True, unbiased=False)
    return (x - m) / torch.sqrt(v + eps)
def _scatter_add(tgt, idx, src, axis=0):
    return tgt.clone().index_add_(axis, idx, src)
def _segment_sum(src, seg, n):
    out = torch.zeros((n,) + src.shape[1:], dtype=src.dtype)
    return out.index_add_(0, seg, src)
def _pad(x, pw):
    flat = tuple(v for pair in reversed(pw) for v in pair)
    return torch.nn.functional.pad(x, flat)

kernel_name = 'sequential_preLN__ssm_conv_h3__geglu_ffn__prompt'

def setup_inputs():

    _w = (lambda a: (lambda t: t.to(torch.bfloat16) if t.is_floating_point() else t)(torch.as_tensor(a)))
    def _A_setup():
        B, S, D = 1, 2048, 448
        ks = 4
        return {
            "q": _w((lambda *s: torch.randn(*s, dtype=torch.bfloat16) * 0.05)(B, S, D)),
            "k": _w((lambda *s: torch.randn(*s, dtype=torch.bfloat16) * 0.4)(B, S, D)),
            "v": _w((lambda *s: torch.randn(*s, dtype=torch.bfloat16) * 0.4)(B, S, D)),
            "shift_k": _w((lambda *s: torch.randn(*s, dtype=torch.bfloat16) * 0.4)(D, ks) * 0.5),
            "ssm_k": _w((lambda *s: torch.randn(*s, dtype=torch.bfloat16) * 0.4)(D, S) * (1.0 / S ** 0.5)),
            "ssm_D": _w((lambda *s: torch.randn(*s, dtype=torch.bfloat16) * 0.4)(D)),
        }
    _A_in = _A_setup()

    def _B_setup():
        B, S, D, F = 1, 2048, 448, 1792
        return {
            "x": _w((lambda *s: torch.randn(*s, dtype=torch.bfloat16) * 0.05)(B, S, D)),
            "w_gate": _w((lambda *s: torch.randn(*s, dtype=torch.bfloat16) * 0.05)(D, F)),
            "w_up": _w((lambda *s: torch.randn(*s, dtype=torch.bfloat16) * 0.05)(D, F)),
            "w_down": _w((lambda *s: torch.randn(*s, dtype=torch.bfloat16) * 0.05)(F, D)),
        }
    _B_in = _B_setup()

    return {
        "A_q": _A_in["q"],
        "A_k": _A_in["k"],
        "A_v": _A_in["v"],
        "A_shift_k": _A_in["shift_k"],
        "A_ssm_k": _A_in["ssm_k"],
        "A_ssm_D": _A_in["ssm_D"],
        "B_x": _B_in["x"],
        "B_w_gate": _B_in["w_gate"],
        "B_w_up": _B_in["w_up"],
        "B_w_down": _B_in["w_down"],
    }

def reference(A_q, A_k, A_v, A_shift_k, A_ssm_k, A_ssm_D, B_x, B_w_gate, B_w_up, B_w_down):
    def _A_ref(q, k, v, shift_k, ssm_k, ssm_D):
        B, S, D = q.shape
        ks = shift_k.shape[-1]
        k_pad = _pad(k, ((0, 0), (ks - 1, 0), (0, 0)))
        k_shift = torch.zeros_like(k)
        for t in range(ks):
            k_shift = k_shift + k_pad[:, t:t + S, :] * shift_k[:, ks - 1 - t][None, None, :]
        kv = k_shift * v
        L = 2 * S
        kv_pad = _pad(kv, ((0, 0), (0, S), (0, 0)))
        kf_pad = _pad(ssm_k, ((0, 0), (0, S)))
        kv_f = (lambda x, axes=(-2,-1): torch.fft.rfft2(x.float(), dim=axes))(kv_pad[:, None, :, :], axes=(1, 2))
        kf_f = (lambda x, axes=(-2,-1): torch.fft.rfft2(x.float(), dim=axes))(kf_pad[:, None, :], axes=(1, 2))
        kf_f = (lambda x, *d: x.permute(*d))(kf_f, 1, 2, 0)
        y_f = kv_f * kf_f[None, :, :, :]
        y = (lambda x, s, axes=(-2,-1): torch.fft.irfft2(x, s=s, dim=axes).to(torch.bfloat16))(y_f, (1, L), axes=(1, 2))[:, 0, :S, :]
        y = y + kv * ssm_D[None, None, :]
        return q * y

    def _B_ref(x, w_gate, w_up, w_down):
        return (_gelu(x @ w_gate) * (x @ w_up)) @ w_down

    x = A_q
    h = x + _A_ref(_layernorm(x, axis=-1), A_k, A_v, A_shift_k, A_ssm_k, A_ssm_D)
    h2 = h + _B_ref(_layernorm(h, axis=-1), B_w_gate, B_w_up, B_w_down)
    return h2
```

```asm
; @launch grid=(256,1,1) block=(512,1,1) lds=163840
.amdgcn_target "amdgcn-amd-amdhsa--gfx950"
.text
.globl sequential_preLN__ssm_conv_h3__geglu_ffn__prompt_kernel
.p2align 8
.type sequential_preLN__ssm_conv_h3__geglu_ffn__prompt_kernel,@function
sequential_preLN__ssm_conv_h3__geglu_ffn__prompt_kernel:
    s_load_dwordx16 s[64:79], s[0:1], 0
    s_load_dwordx8 s[80:87], s[0:1], 64
    s_load_dwordx2 s[88:89], s[0:1], 96
    v_lshrrev_b32 v1, 6, v0
    v_and_b32 v0, 63, v0
    s_lshr_b32 s49, s2, 5
    v_readfirstlane_b32 s48, v1
    s_and_b32 s50, s2, 31
    s_cmp_ge_u32 s49, 7
    s_cbranch_scc1 L_helper
    s_mov_b32 s10, 1835008
    s_mov_b32 s11, 0x20000
    s_mov_b32 s14, s10
    s_mov_b32 s15, s11
    s_lshl3_add_u32 s53, s50, s48
    s_mulk_i32 s53, 7168
    s_lshl_b32 s52, s49, 7
    s_add_u32 s53, s53, s52
    v_lshrrev_b32 v2, 3, v0
    v_and_b32 v3, 7, v0
    v_lshrrev_b32 v8, 4, v0
    v_xor_b32 v8, v8, v3
    v_lshlrev_b32 v8, 4, v8
    s_movk_i32 s56, 896
    v_mad_u32_u24 v14, v2, s56, v8
    s_andn2_b32 s57, 1, s48
    s_lshl_b32 s57, s57, 6
    v_xor_b32 v9, s57, v14
    s_lshl_b32 s54, s48, 10
    s_add_u32 m0, s54, 25600
    s_waitcnt lgkmcnt(0)
    s_mov_b64 s[8:9], s[66:67]
    s_mov_b64 s[12:13], s[68:69]
    buffer_load_dwordx4 v9, s[8:11], s53 offen nt lds
    s_add_u32 m0, s54, 16384
    s_sub_u32 s57, s53, 7168
    buffer_load_dwordx4 v9, s[12:15], s53 offen nt lds
    v_add_u32 v14, s57, v14
    s_cmp_lg_u32 s48, 0
    s_cbranch_scc1 halo_3
    s_mov_b32 m0, 24576
    s_mov_b32 exec_lo, 0
    s_mov_b32 exec_hi, 0xffffff00
    buffer_load_dwordx4 v14, s[8:11], 0 offen nt lds
    s_mov_b64 exec, -1
halo_3:
    s_and_b32 s51, s48, 1
    s_lshl_b32 s58, s49, 9
    s_lshl_b32 s57, s48, 6
    s_add_u32 s58, s58, s57
    s_waitcnt lgkmcnt(0)
    s_mov_b64 s[4:5], s[64:65]
    s_mov_b32 s6, 1835008
    s_mov_b32 s7, 0x20000
    s_mov_b64 s[40:41], s[88:89]
    s_mov_b32 s42, 33554432
    s_mov_b32 s43, 0x20000
    s_mov_b64 s[20:21], s[72:73]
    s_mov_b32 s22, 1835008
    s_mov_b32 s23, 0x20000
    s_mov_b64 s[24:25], s[78:79]
    s_mov_b32 s26, 1605632
    s_mov_b32 s27, 0x20000
    s_mov_b64 s[28:29], s[80:81]
    s_mov_b32 s30, 1605632
    s_mov_b32 s31, 0x20000
    s_mov_b64 s[32:33], s[82:83]
    s_mov_b32 s34, 1605632
    s_mov_b32 s35, 0x20000
    s_mov_b64 s[36:37], s[84:85]
    s_mov_b32 s38, 1835008
    s_mov_b32 s39, 0x20000
    s_mov_b32 s46, 1605632
    s_mov_b32 s47, 0x20000
    s_bitcmp1_b32 s48, 0
    s_cselect_b64 s[44:45], s[80:81], s[78:79]
    s_lshl_b32 s62, s2, 2
    s_load_dword s95, s[74:75], s62
    s_mov_b32 s56, 1998848
    s_load_dword s3, s[88:89], s56
    s_mov_b64 s[62:63], s[70:71]
    s_load_dwordx16 s[64:79], s[62:63], s58
    v_bfe_u32 v10, v0, 4, 1
    s_and_b32 s57, s48, 3
    s_lshl_b32 s57, s57, 1
    v_or_b32 v10, s57, v10
    v_xor_b32 v10, v10, v3
    v_lshlrev_b32 v10, 4, v10
    s_movk_i32 s56, 896
    v_mad_u32_u24 v12, v2, s56, v10
    v_lshlrev_b32 v13, 4, v0
    s_lshl_b32 s59, s2, 1
    s_add_u32 s59, s59, s51
    s_barrier
    s_add_u32 m0, s54, 8192
    s_nop 0
    buffer_load_dwordx4 v12, s[4:7], s53 offen nt lds
    s_lshr_b32 s57, s48, 1
    s_lshl_b32 s57, s57, 10
    s_lshl_b32 s56, s59, 12
    s_add_u32 s56, s56, s57
    s_mul_i32 s58, s51, 4160
    s_add_u32 s57, s57, s58
    s_add_u32 m0, s57, 131136
    v_min_u32 v60, 27, v0
    buffer_load_dwordx4 v13, s[20:23], s56 offen nt lds
    v_lshlrev_b32 v60, 7, v60
    s_lshl_b32 s56, s2, 3
    s_add_u32 s56, s56, s48
    s_mul_i32 s56, s56, 896
    v_lshlrev_b32 v92, 4, v0
    v_mov_b32 v88, 0
    v_mov_b32 v89, 0
    v_mov_b32 v90, 0
    v_mov_b32 v91, 0
    s_mov_b32 exec_hi, 0x00ffffff
    buffer_load_dwordx4 v[88:91], v92, s[4:7], s56 offen nt
    s_mov_b64 exec, -1
    s_cmp_lt_u32 s48, 6
    s_cbranch_scc1 ini_4
    v_mov_b32 v52, 0
    v_mov_b32 v53, 0
    v_and_b32 v4, 31, v0
    v_lshlrev_b32 v4, 3, v4
    s_mul_i32 s57, s51, 4352
    s_add_u32 s57, s57, 147456
    v_add_u32 v5, s57, v4
    ds_write_b64 v5, v[52:53]
    v_and_b32 v4, 63, v4
    s_add_u32 s58, s58, 131072
    v_add_u32 v5, s58, v4
    ds_write_b64 v5, v[52:53]
    v_and_b32 v4, 15, v4
    s_mul_i32 s57, s51, 640
    s_add_u32 s57, s57, 156160
    v_add_u32 v5, s57, v4
    ds_write_b64 v5, v[52:53]
    v_add_u32 v5, 163776, v4
    ds_write_b64 v5, v[52:53]
ini_4:
    s_and_b32 s94, s2, 7
    s_lshr_b32 s57, s2, 3
    s_lshr_b32 s92, s94, 2
    s_bfe_u32 s56, s94, 0x10001
    s_lshr_b32 s93, s57, 3
    s_lshl2_add_u32 s91, s56, s93
    s_cmp_ge_u32 s57, 24
    s_cselect_b32 s93, 3, s91
    s_and_b32 s91, s57, 3
    s_lshl2_add_u32 s91, s56, s91
    s_and_b32 s90, s57, 7
    s_cmp_ge_u32 s57, 24
    s_cselect_b32 s90, s91, s90
    s_and_b32 s56, s94, 1
    s_lshl_b32 s56, s56, 3
    s_add_u32 s90, s90, s56
    s_mul_i32 s91, s92, 7
    s_add_u32 s91, s91, s93
    v_add_u32 v6, 5, v0
    v_bfe_u32 v7, v6, 1, 3
    v_xor_b32 v7, s48, v7
    v_lshlrev_b32 v7, 4, v7
    v_lshl_add_u32 v16, v6, 7, v7
    v_add_u32 v6, 6, v0
    v_bfe_u32 v7, v6, 1, 3
    v_xor_b32 v7, s48, v7
    v_lshlrev_b32 v7, 4, v7
    v_lshl_add_u32 v17, v6, 7, v7
    v_add_u32 v6, 7, v0
    v_bfe_u32 v7, v6, 1, 3
    v_xor_b32 v7, s48, v7
    v_lshlrev_b32 v7, 4, v7
    v_lshl_add_u32 v18, v6, 7, v7
    v_add_u32 v6, 8, v0
    v_bfe_u32 v7, v6, 1, 3
    v_xor_b32 v7, s48, v7
    v_lshlrev_b32 v7, 4, v7
    v_lshl_add_u32 v19, v6, 7, v7
    v_add_u32 v20, 15360, v19
    v_add_u32 v16, 24576, v16
    v_add_u32 v17, 24576, v17
    v_add_u32 v18, 24576, v18
    v_add_u32 v19, 24576, v19
    v_add_u32 v11, s54, v13
    v_lshrrev_b32 v6, 4, v0
    v_bfe_u32 v7, v0, 1, 1
    v_lshl_add_u32 v6, v6, 1, v7
    v_bfe_u32 v7, v0, 2, 2
    v_lshl_add_u32 v4, v6, 3, v7
    v_and_b32 v8, 1, v0
    v_lshlrev_b32 v8, 3, v8
    v_lshl_add_u32 v21, v4, 4, v8
    v_add_u32 v21, s54, v21
    v_lshl_add_u32 v4, v4, 7, v8
    v_and_b32 v6, 3, v6
    v_lshrrev_b32 v7, 1, v7
    v_lshl_add_u32 v6, v6, 1, v7
    v_xor_b32 v6, s48, v6
    v_lshl_add_u32 v4, v6, 4, v4
    v_add_u32 v4, 8192, v4
    v_lshlrev_b32 v6, 12, v3
    v_lshl_add_u32 v5, v2, 4, v6
    s_lshl_b32 s55, s49, 3
    s_add_u32 s55, s55, s48
    s_lshl_b32 s55, s55, 15
    s_lshl_b32 s56, s50, 7
    s_add_u32 s55, s55, s56
    s_add_u32 s61, s55, 2097152
    s_lshl_b32 s60, s2, 6
    s_add_u32 s60, s60, 1900544
    v_mov_b32 v22, 0x05040100
    v_mov_b32 v23, 0x07060302
    v_mov_b32 v10, 0xffff0000
    s_waitcnt lgkmcnt(0)
    s_mul_i32 s3, s3, 0x9E3779B1
    s_add_u32 s3, s3, 0x7F4A7C15
    s_waitcnt vmcnt(3)
    s_barrier
    ds_read_b128 v[24:27], v16
    ds_read_b128 v[28:31], v17
    ds_read_b128 v[32:35], v18
    ds_read_b128 v[36:39], v19
    ds_read_b128 v[40:43], v20
    s_waitcnt lgkmcnt(3)
    v_perm_b32 v64, v24, v28, v22
    v_perm_b32 v65, v24, v28, v23
    v_perm_b32 v66, v25, v29, v22
    v_perm_b32 v67, v25, v29, v23
    v_perm_b32 v68, v26, v30, v22
    v_perm_b32 v69, v26, v30, v23
    v_perm_b32 v70, v27, v31, v22
    v_perm_b32 v71, v27, v31, v23
    s_waitcnt lgkmcnt(1)
    v_perm_b32 v72, v32, v36, v22
    v_perm_b32 v73, v32, v36, v23
    v_perm_b32 v74, v33, v37, v22
    v_perm_b32 v75, v33, v37, v23
    v_perm_b32 v76, v34, v38, v22
    v_perm_b32 v77, v34, v38, v23
    v_perm_b32 v78, v35, v39, v22
    v_perm_b32 v79, v35, v39, v23
    v_dot2_f32_bf16 v80, v64, s65, 0
    v_dot2_f32_bf16 v81, v65, s67, 0
    v_dot2_f32_bf16 v82, v66, s69, 0
    v_dot2_f32_bf16 v83, v67, s71, 0
    v_dot2_f32_bf16 v84, v68, s73, 0
    v_dot2_f32_bf16 v85, v69, s75, 0
    v_dot2_f32_bf16 v86, v70, s77, 0
    v_dot2_f32_bf16 v87, v71, s79, 0
    s_waitcnt lgkmcnt(0)
    v_lshlrev_b32 v44, 16, v40
    v_and_b32 v45, v10, v40
    v_lshlrev_b32 v46, 16, v41
    v_and_b32 v47, v10, v41
    v_lshlrev_b32 v48, 16, v42
    v_and_b32 v49, v10, v42
    v_lshlrev_b32 v50, 16, v43
    v_and_b32 v51, v10, v43
    v_dot2c_f32_bf16 v80, s64, v72
    v_dot2c_f32_bf16 v81, s66, v73
    v_dot2c_f32_bf16 v82, s68, v74
    v_dot2c_f32_bf16 v83, s70, v75
    v_dot2c_f32_bf16 v84, s72, v76
    v_dot2c_f32_bf16 v85, s74, v77
    v_dot2c_f32_bf16 v86, s76, v78
    v_dot2c_f32_bf16 v87, s78, v79
    v_mul_f32 v80, v80, v44
    v_mul_f32 v81, v81, v45
    v_mul_f32 v82, v82, v46
    v_mul_f32 v83, v83, v47
    v_mul_f32 v84, v84, v48
    v_mul_f32 v85, v85, v49
    v_mul_f32 v86, v86, v50
    v_mul_f32 v87, v87, v51
    v_cvt_pk_bf16_f32 v64, v80, v81
    v_cvt_pk_bf16_f32 v65, v82, v83
    v_cvt_pk_bf16_f32 v66, v84, v85
    v_cvt_pk_bf16_f32 v67, v86, v87
    ds_write_b128 v11, v[64:67]
    ds_read_b64_tr_b16 v[68:69], v21
    ds_read_b64_tr_b16 v[70:71], v21 offset:64
    s_waitcnt lgkmcnt(0)
    buffer_store_dwordx4 v[68:71], v5, s[40:43], s55 offen sc1
    s_waitcnt vmcnt(3)
    s_barrier
    ds_read_b64_tr_b16 v[72:73], v4
    ds_read_b64_tr_b16 v[74:75], v4 offset:512
    s_waitcnt lgkmcnt(0)
    buffer_store_dwordx4 v[72:75], v5, s[40:43], s61 offen sc1
    s_cmp_lt_u32 s48, 4
    s_cbranch_scc1 sh_5
    s_cmp_ge_u32 s48, 6
    s_cselect_b32 s55, 224, 0
    s_add_u32 s55, s55, s2
    s_mul_i32 s55, s55, 3584
    s_waitcnt vmcnt(2)
    buffer_load_dword v61, v60, s[44:47], s55 offen
    s_branch sh_5x
sh_5:
    s_waitcnt vmcnt(2)
sh_5x:
    s_mov_b32 s56, 0x3f803f80
    v_dot2_f32_bf16 v92, v88, s56, 0
    v_dot2_f32_bf16 v93, v88, v88, 0
    v_dot2_f32_bf16 v92, v89, s56, v92
    v_dot2_f32_bf16 v93, v89, v89, v93
    v_dot2_f32_bf16 v92, v90, s56, v92
    v_dot2_f32_bf16 v93, v90, v90, v93
    v_dot2_f32_bf16 v92, v91, s56, v92
    v_dot2_f32_bf16 v93, v91, v91, v93
    s_lshr_b32 s56, s2, 6
    s_lshr_b32 s57, s48, 1
    s_lshl2_add_u32 s56, s56, s57
    v_permlane32_swap_b32 v92, v93
    v_add_f32 v92, v92, v93
    s_lshl_b32 s56, s56, 10
    s_and_b32 s57, s2, 63
    v_add_f32_dpp v92, v92, v92 row_ror:8 row_mask:0xf bank_mask:0xf
    s_lshl4_add_u32 s56, s57, s56
    s_and_b32 s57, s48, 1
    v_add_f32_dpp v92, v92, v92 row_ror:4 row_mask:0xf bank_mask:0xf
    s_lshl_b32 s57, s57, 3
    s_add_u32 s56, s56, s57
    v_add_f32_dpp v92, v92, v92 row_ror:2 row_mask:0xf bank_mask:0xf
    s_add_u32 s56, s56, 1835008
    s_nop 0
    v_add_f32_dpp v92, v92, v92 row_ror:1 row_mask:0xf bank_mask:0xf
    v_mov_b32 v93, v92
    s_nop 1
    v_permlane16_swap_b32 v92, v93
    v_add_f32 v92, v92, v93
    v_mov_b32 v93, v92
    s_nop 1
    v_permlane32_swap_b32 v92, v93
    v_mul_f32 v92, 0xbb124925, v92
    v_mul_f32 v93, 0x3b124925, v93
    v_fma_f32 v93, -v92, v92, v93
    v_max_f32 v93, 0, v93
    v_cvt_pk_bf16_f32 v93, v92, v93
    v_lshlrev_b32 v92, 16, v93
    v_and_b32 v93, 0xffff0000, v93
    v_add_f32 v93, 0x3727c5ac, v93
    v_cvt_pk_bf16_f32 v93, v93, v93
    v_lshlrev_b32 v93, 16, v93
    v_sqrt_f32 v93, v93
    s_nop 0
    v_cvt_pk_bf16_f32 v93, v93, v93
    v_lshlrev_b32 v93, 16, v93
    v_lshrrev_b32 v92, 16, v92
    v_or_b32 v92, v92, v93
    v_mov_b32 v93, s3
    s_mov_b64 exec, 1
    buffer_store_dwordx2 v[92:93], off, s[40:43], s56 sc1
    s_mov_b64 exec, -1
    s_cmp_ge_u32 s48, 4
    s_cbranch_scc1 fx_1
    v_mov_b32 v224, 0
    v_mov_b32 v225, 0
    v_mov_b32 v226, 0
    v_mov_b32 v227, 0
    v_mov_b32 v228, 0
    v_mov_b32 v229, 0
    v_mov_b32 v230, 0
    v_mov_b32 v231, 0
    v_mov_b32 v232, 0
    v_mov_b32 v233, 0
    v_mov_b32 v234, 0
    v_mov_b32 v235, 0
    v_mov_b32 v236, 0
    v_mov_b32 v237, 0
    v_mov_b32 v238, 0
    v_mov_b32 v239, 0
    s_lshr_b32 s49, s48, 1
    s_and_b32 s50, s48, 1
    v_lshrrev_b32 v5, 4, v0
    v_bfe_u32 v6, v0, 2, 2
    v_and_b32 v7, 3, v0
    v_lshl_add_u32 v5, v5, 3, v6
    v_lshlrev_b32 v12, 2, v7
    v_sub_u32 v12, v12, v5
    v_lshlrev_b32 v12, 3, v12
    s_mul_i32 s54, s49, 4352
    s_lshl_b32 s56, s50, 7
    s_add_u32 s56, s56, s54
    s_add_u32 s56, s56, 147704
    v_add_u32 v12, s56, v12
    v_add_u32 v13, v5, v7
    v_lshlrev_b32 v13, 3, v13
    s_mul_i32 s55, s49, 4160
    s_add_u32 s56, s55, 131112
    v_add_u32 v13, s56, v13
    s_lshl_b32 s56, s49, 13
    s_lshl_b32 s58, s50, 8
    s_add_u32 s56, s56, s58
    s_add_u32 s56, s56, 131072
    v_lshlrev_b32 v15, 2, v0
    v_add_u32 v14, s56, v15
    s_mul_i32 s56, s49, 640
    s_lshl4_add_u32 s56, s50, s56
    s_add_u32 s56, s56, 155936
    v_add_u32 v15, s56, v15
    s_and_b32 s61, s2, 0xe0
    s_lshl_b32 s61, s61, 6
    s_add_u32 s61, s61, 1900544
    s_waitcnt vmcnt(1)
    s_barrier
    s_cmp_lg_u32 s48, 0
    s_cbranch_scc1 nw0_6
    v_mov_b32 v2, s3
    s_mov_b64 exec, 1
    buffer_store_dword v2, off, s[40:43], s60 sc1
    s_mov_b64 exec, -1
nw0_6:
    ds_read_b64_tr_b16 v[144:145], v13 offset:0
    ds_read_b64_tr_b16 v[146:147], v13 offset:32
    ds_read_b64_tr_b16 v[148:149], v13 offset:256
    ds_read_b64_tr_b16 v[150:151], v13 offset:288
    ds_read_b64_tr_b16 v[152:153], v13 offset:512
    ds_read_b64_tr_b16 v[154:155], v13 offset:544
    ds_read_b64_tr_b16 v[156:157], v13 offset:768
    ds_read_b64_tr_b16 v[158:159], v13 offset:800
    ds_read_b64_tr_b16 v[160:161], v13 offset:1024
    ds_read_b64_tr_b16 v[162:163], v13 offset:1056
    ds_read_b64_tr_b16 v[164:165], v13 offset:1280
    ds_read_b64_tr_b16 v[166:167], v13 offset:1312
    ds_read_b64_tr_b16 v[168:169], v13 offset:1536
    ds_read_b64_tr_b16 v[170:171], v13 offset:1568
    ds_read_b64_tr_b16 v[172:173], v13 offset:1792
    ds_read_b64_tr_b16 v[174:175], v13 offset:1824
    ds_read_b64_tr_b16 v[176:177], v13 offset:2048
    ds_read_b64_tr_b16 v[178:179], v13 offset:2080
    ds_read_b64_tr_b16 v[180:181], v13 offset:2304
    ds_read_b64_tr_b16 v[182:183], v13 offset:2336
    ds_read_b64_tr_b16 v[184:185], v13 offset:2560
    ds_read_b64_tr_b16 v[186:187], v13 offset:2592
    ds_read_b64_tr_b16 v[188:189], v13 offset:2816
    ds_read_b64_tr_b16 v[190:191], v13 offset:2848
    ds_read_b64_tr_b16 v[192:193], v13 offset:3072
    ds_read_b64_tr_b16 v[194:195], v13 offset:3104
    ds_read_b64_tr_b16 v[196:197], v13 offset:3328
    ds_read_b64_tr_b16 v[198:199], v13 offset:3360
    ds_read_b64_tr_b16 v[200:201], v13 offset:3584
    ds_read_b64_tr_b16 v[202:203], v13 offset:3616
    ds_read_b64_tr_b16 v[204:205], v13 offset:3840
    ds_read_b64_tr_b16 v[206:207], v13 offset:3872
    s_barrier
    s_cmp_lg_u32 s48, 0
    s_cbranch_scc1 nw0_7
    v_lshlrev_b32 v3, 4, v0
    s_lshl_b32 s62, s2, 13
    s_add_u32 s63, s62, 4096
    s_mov_b32 m0, 147712
    v_min_u32 v2, 31, v0
    v_lshlrev_b32 v4, 6, v2
    buffer_load_dword v8, v4, s[40:43], s61 offen sc1
    s_mov_b32 s57, 0
poll_8:
    s_waitcnt vmcnt(0)
    v_cmp_ne_u32 s[64:65], s3, v8
    s_cmp_eq_u64 s[64:65], 0
    s_cbranch_scc1 pd_9
    s_add_u32 s57, s57, 1
    s_cmp_gt_u32 s57, 0x40000
    s_cbranch_scc1 pd_9
    s_mov_b64 exec, s[64:65]
    s_cbranch_execz ps_10
    buffer_load_dword v8, v4, s[40:43], s61 offen sc1
ps_10:
    s_mov_b64 exec, -1
    s_branch poll_8
pd_9:
    buffer_load_dwordx4 v3, s[40:43], s62 offen offset:0 sc1 lds
    buffer_load_dwordx4 v3, s[40:43], s62 offen offset:1024 sc1 lds
    buffer_load_dwordx4 v3, s[40:43], s62 offen offset:2048 sc1 lds
    buffer_load_dwordx4 v3, s[40:43], s62 offen offset:3072 sc1 lds
    s_mov_b32 m0, 152064
    s_nop 0
    buffer_load_dwordx4 v3, s[40:43], s63 offen offset:0 sc1 lds
    buffer_load_dwordx4 v3, s[40:43], s63 offen offset:1024 sc1 lds
    buffer_load_dwordx4 v3, s[40:43], s63 offen offset:2048 sc1 lds
    buffer_load_dwordx4 v3, s[40:43], s63 offen offset:3072 sc1 lds
nw0_7:
    s_mov_b32 s58, 0
    s_mov_b32 s59, 0xe0000000
    s_setprio 2
    s_barrier
    v_bfe_u32 v4, v0, 4, 1
    v_lshrrev_b32 v5, 5, v0
    v_bfe_u32 v6, v0, 2, 2
    v_and_b32 v7, 3, v0
    v_lshl_add_u32 v8, v6, 1, v4
    v_xor_b32 v8, s48, v8
    v_lshlrev_b32 v8, 5, v8
    v_lshl_add_u32 v8, v7, 3, v8
    v_lshl_add_u32 v5, v5, 3, v6
    v_lshl_add_u32 v8, v5, 8, v8
    v_lshl_add_u32 v8, v4, 13, v8
    v_add_u32 v9, 0x10000, v8
    v_mov_b32 v10, 163784
    v_mov_b32 v11, 1
    s_lshl_b32 s56, s95, 16
    s_and_b32 s57, s95, 0xffff0000
    s_cmp_eq_u32 s49, 0
    s_cselect_b32 s56, s56, s57
    v_mov_b32 v2, s56
    s_lshl_b32 s56, s50, 7
    s_add_u32 s56, s56, s54
    s_add_u32 s56, s56, 147712
    v_lshl_add_u32 v3, v0, 1, s56
    s_waitcnt vmcnt(0)
    s_waitcnt lgkmcnt(0)
    s_barrier
    ds_read_b64_tr_b16 v[16:17], v12 offset:32
    ds_read_b64_tr_b16 v[18:19], v12 offset:0
    ds_read_b64_tr_b16 v[20:21], v12 offset:288
    ds_read_b64_tr_b16 v[22:23], v12 offset:256
    ds_read_b64_tr_b16 v[24:25], v12 offset:544
    ds_read_b64_tr_b16 v[26:27], v12 offset:512
    ds_read_b64_tr_b16 v[28:29], v12 offset:800
    ds_read_b64_tr_b16 v[30:31], v12 offset:768
    ds_read_b64_tr_b16 v[32:33], v12 offset:1056
    ds_read_b64_tr_b16 v[34:35], v12 offset:1024
    ds_read_u16_d16_hi v224, v3 offset:0
    ds_read_u16_d16_hi v225, v3 offset:256
    ds_read_b64_tr_b16 v[36:37], v12 offset:1312
    ds_read_b64_tr_b16 v[38:39], v12 offset:1280
    s_waitcnt lgkmcnt(12)
    v_mfma_f32_16x16x32_bf16 v[80:83], v[16:19], v[144:147], 0
    ds_read_u16_d16_hi v226, v3 offset:512
    v_mfma_f32_16x16x32_bf16 v[84:87], v[16:19], v[148:151], 0
    ds_read_u16_d16_hi v227, v3 offset:768
    s_waitcnt lgkmcnt(12)
    v_mfma_f32_16x16x32_bf16 v[84:87], v[20:23], v[144:147], v[84:87]
    ds_read_b64_tr_b16 v[40:41], v12 offset:1568
    v_mfma_f32_16x16x32_bf16 v[88:91], v[16:19], v[152:155], 0
    ds_read_b64_tr_b16 v[42:43], v12 offset:1536
    v_mfma_f32_16x16x32_bf16 v[88:91], v[20:23], v[148:151], v[88:91]
    ds_read_u16_d16_hi v228, v3 offset:1024
    s_waitcnt lgkmcnt(13)
    v_mfma_f32_16x16x32_bf16 v[88:91], v[24:27], v[144:147], v[88:91]
    ds_read_u16_d16_hi v229, v3 offset:1280
    v_mfma_f32_16x16x32_bf16 v[92:95], v[16:19], v[156:159], 0
    ds_read_b64_tr_b16 v[44:45], v12 offset:1824
    v_mfma_f32_16x16x32_bf16 v[92:95], v[20:23], v[152:155], v[92:95]
    ds_read_b64_tr_b16 v[46:47], v12 offset:1792
    v_mfma_f32_16x16x32_bf16 v[92:95], v[24:27], v[148:151], v[92:95]
    ds_read_b64_tr_b16 v[48:49], v12 offset:2080
    s_waitcnt lgkmcnt(15)
    v_mfma_f32_16x16x32_bf16 v[92:95], v[28:31], v[144:147], v[92:95]
    ds_read_b64_tr_b16 v[50:51], v12 offset:2048
    v_mfma_f32_16x16x32_bf16 v[96:99], v[16:19], v[160:163], 0
    v_add_f32_dpp v208, v81, v82 wave_shl:1 row_mask:0xf bank_mask:0xf bound_ctrl:0
    v_add_f32_dpp v209, v85, v86 wave_shl:1 row_mask:0xf bank_mask:0xf bound_ctrl:0
    v_mfma_f32_16x16x32_bf16 v[96:99], v[20:23], v[156:159], v[96:99]
    v_add_f32_dpp v82, v83, v82 wave_shr:1 row_mask:0xf bank_mask:0xf bound_ctrl:0
    v_add_f32_dpp v86, v87, v86 wave_shr:1 row_mask:0xf bank_mask:0xf bound_ctrl:0
    v_mfma_f32_16x16x32_bf16 v[96:99], v[24:27], v[152:155], v[96:99]
    v_add_f32_dpp v208, v208, v83 wave_shl:1 row_mask:0xf bank_mask:0xf bound_ctrl:0
    v_add_f32_dpp v209, v209, v87 wave_shl:1 row_mask:0xf bank_mask:0xf bound_ctrl:0
    v_mfma_f32_16x16x32_bf16 v[96:99], v[28:31], v[148:151], v[96:99]
    v_add_f32_dpp v81, v82, v81 wave_shr:1 row_mask:0xf bank_mask:0xf bound_ctrl:0
    v_add_f32_dpp v85, v86, v85 wave_shr:1 row_mask:0xf bank_mask:0xf bound_ctrl:0
    s_waitcnt lgkmcnt(14)
    v_mfma_f32_16x16x32_bf16 v[96:99], v[32:35], v[144:147], v[96:99]
    s_waitcnt lgkmcnt(12)
    v_fmac_f32 v80, v2, v224
    v_fmac_f32 v84, v2, v225
    v_mfma_f32_16x16x32_bf16 v[100:103], v[16:19], v[164:167], 0
    v_add_f32_dpp v80, v81, v80 wave_shr:1 row_mask:0xf bank_mask:0xf bound_ctrl:0
    v_add_f32_dpp v84, v85, v84 wave_shr:1 row_mask:0xf bank_mask:0xf bound_ctrl:0
    v_mfma_f32_16x16x32_bf16 v[100:103], v[20:23], v[160:163], v[100:103]
    s_mov_b64 exec, s[58:59]
    ds_write2_b32 v15, v208, v209 offset0:0 offset1:8
    s_mov_b64 exec, -1
    v_mfma_f32_16x16x32_bf16 v[100:103], v[24:27], v[156:159], v[100:103]
    ds_write2st64_b32 v14, v80, v84 offset0:0 offset1:2
    v_mfma_f32_16x16x32_bf16 v[100:103], v[28:31], v[152:155], v[100:103]
    v_add_f32_dpp v210, v89, v90 wave_shl:1 row_mask:0xf bank_mask:0xf bound_ctrl:0
    v_add_f32_dpp v211, v93, v94 wave_shl:1 row_mask:0xf bank_mask:0xf bound_ctrl:0
    v_mfma_f32_16x16x32_bf16 v[100:103], v[32:35], v[148:151], v[100:103]
    ds_read_u16_d16_hi v230, v3 offset:1536
    s_waitcnt lgkmcnt(13)
    v_mfma_f32_16x16x32_bf16 v[100:103], v[36:39], v[144:147], v[100:103]
    ds_read_u16_d16_hi v231, v3 offset:1792
    v_mfma_f32_16x16x32_bf16 v[104:107], v[16:19], v[168:171], 0
    v_add_f32_dpp v90, v91, v90 wave_shr:1 row_mask:0xf bank_mask:0xf bound_ctrl:0
    v_add_f32_dpp v94, v95, v94 wave_shr:1 row_mask:0xf bank_mask:0xf bound_ctrl:0
    v_mfma_f32_16x16x32_bf16 v[104:107], v[20:23], v[164:167], v[104:107]
    v_add_f32_dpp v210, v210, v91 wave_shl:1 row_mask:0xf bank_mask:0xf bound_ctrl:0
    v_add_f32_dpp v211, v211, v95 wave_shl:1 row_mask:0xf bank_mask:0xf bound_ctrl:0
    v_mfma_f32_16x16x32_bf16 v[104:107], v[24:27], v[160:163], v[104:107]
    v_add_f32_dpp v89, v90, v89 wave_shr:1 row_mask:0xf bank_mask:0xf bound_ctrl:0
    v_add_f32_dpp v93, v94, v93 wave_shr:1 row_mask:0xf bank_mask:0xf bound_ctrl:0
    v_mfma_f32_16x16x32_bf16 v[104:107], v[28:31], v[156:159], v[104:107]
    ds_read_b64_tr_b16 v[52:53], v12 offset:2336
    v_mfma_f32_16x16x32_bf16 v[104:107], v[32:35], v[152:155], v[104:107]
    ds_read_b64_tr_b16 v[54:55], v12 offset:2304
    v_mfma_f32_16x16x32_bf16 v[104:107], v[36:39], v[148:151], v[104:107]
    s_waitcnt lgkmcnt(14)
    v_fmac_f32 v88, v2, v226
    v_fmac_f32 v92, v2, v227
    s_waitcnt lgkmcnt(12)
    v_mfma_f32_16x16x32_bf16 v[104:107], v[40:43], v[144:147], v[104:107]
    v_add_f32_dpp v88, v89, v88 wave_shr:1 row_mask:0xf bank_mask:0xf bound_ctrl:0
    v_add_f32_dpp v92, v93, v92 wave_shr:1 row_mask:0xf bank_mask:0xf bound_ctrl:0
    v_mfma_f32_16x16x32_bf16 v[108:111], v[16:19], v[172:175], 0
    s_mov_b64 exec, s[58:59]
    ds_write2_b32 v15, v210, v211 offset0:16 offset1:24
    s_mov_b64 exec, -1
    v_mfma_f32_16x16x32_bf16 v[108:111], v[20:23], v[168:171], v[108:111]
    ds_write2st64_b32 v14, v88, v92 offset0:4 offset1:6
    v_mfma_f32_16x16x32_bf16 v[108:111], v[24:27], v[164:167], v[108:111]
    v_add_f32_dpp v212, v97, v98 wave_shl:1 row_mask:0xf bank_mask:0xf bound_ctrl:0
    v_add_f32_dpp v213, v101, v102 wave_shl:1 row_mask:0xf bank_mask:0xf bound_ctrl:0
    v_mfma_f32_16x16x32_bf16 v[108:111], v[28:31], v[160:163], v[108:111]
    v_add_f32_dpp v98, v99, v98 wave_shr:1 row_mask:0xf bank_mask:0xf bound_ctrl:0
    v_add_f32_dpp v102, v103, v102 wave_shr:1 row_mask:0xf bank_mask:0xf bound_ctrl:0
    v_mfma_f32_16x16x32_bf16 v[108:111], v[32:35], v[156:159], v[108:111]
    v_add_f32_dpp v212, v212, v99 wave_shl:1 row_mask:0xf bank_mask:0xf bound_ctrl:0
    v_add_f32_dpp v213, v213, v103 wave_shl:1 row_mask:0xf bank_mask:0xf bound_ctrl:0
    v_mfma_f32_16x16x32_bf16 v[108:111], v[36:39], v[152:155], v[108:111]
    v_add_f32_dpp v97, v98, v97 wave_shr:1 row_mask:0xf bank_mask:0xf bound_ctrl:0
    v_add_f32_dpp v101, v102, v101 wave_shr:1 row_mask:0xf bank_mask:0xf bound_ctrl:0
    v_mfma_f32_16x16x32_bf16 v[108:111], v[40:43], v[148:151], v[108:111]
    s_waitcnt lgkmcnt(12)
    v_fmac_f32 v96, v2, v228
    v_fmac_f32 v100, v2, v229
    s_waitcnt lgkmcnt(10)
    v_mfma_f32_16x16x32_bf16 v[108:111], v[44:47], v[144:147], v[108:111]
    ds_read_b64_tr_b16 v[56:57], v12 offset:2592
    v_mfma_f32_16x16x32_bf16 v[112:115], v[16:19], v[176:179], 0
    ds_read_b64_tr_b16 v[58:59], v12 offset:2560
    v_mfma_f32_16x16x32_bf16 v[112:115], v[20:23], v[172:175], v[112:115]
    v_add_f32_dpp v96, v97, v96 wave_shr:1 row_mask:0xf bank_mask:0xf bound_ctrl:0
    v_add_f32_dpp v100, v101, v100 wave_shr:1 row_mask:0xf bank_mask:0xf bound_ctrl:0
    v_mfma_f32_16x16x32_bf16 v[112:115], v[24:27], v[168:171], v[112:115]
    ds_read_u16_d16_hi v232, v3 offset:2048
    v_mfma_f32_16x16x32_bf16 v[112:115], v[28:31], v[164:167], v[112:115]
    ds_read_u16_d16_hi v233, v3 offset:2304
    v_mfma_f32_16x16x32_bf16 v[112:115], v[32:35], v[160:163], v[112:115]
    s_mov_b64 exec, s[58:59]
    ds_write2_b32 v15, v212, v213 offset0:32 offset1:40
    s_mov_b64 exec, -1
    v_mfma_f32_16x16x32_bf16 v[112:115], v[36:39], v[156:159], v[112:115]
    ds_write2st64_b32 v14, v96, v100 offset0:8 offset1:10
    v_mfma_f32_16x16x32_bf16 v[112:115], v[40:43], v[152:155], v[112:115]
    ds_read_b64_tr_b16 v[60:61], v12 offset:2848
    v_mfma_f32_16x16x32_bf16 v[112:115], v[44:47], v[148:151], v[112:115]
    v_add_f32_dpp v214, v105, v106 wave_shl:1 row_mask:0xf bank_mask:0xf bound_ctrl:0
    v_add_f32_dpp v215, v109, v110 wave_shl:1 row_mask:0xf bank_mask:0xf bound_ctrl:0
    s_waitcnt lgkmcnt(15)
    v_mfma_f32_16x16x32_bf16 v[112:115], v[48:51], v[144:147], v[112:115]
    v_add_f32_dpp v106, v107, v106 wave_shr:1 row_mask:0xf bank_mask:0xf bound_ctrl:0
    v_add_f32_dpp v110, v111, v110 wave_shr:1 row_mask:0xf bank_mask:0xf bound_ctrl:0
    v_mfma_f32_16x16x32_bf16 v[116:119], v[16:19], v[180:183], 0
    v_add_f32_dpp v214, v214, v107 wave_shl:1 row_mask:0xf bank_mask:0xf bound_ctrl:0
    v_add_f32_dpp v215, v215, v111 wave_shl:1 row_mask:0xf bank_mask:0xf bound_ctrl:0
    v_mfma_f32_16x16x32_bf16 v[116:119], v[20:23], v[176:179], v[116:119]
    v_add_f32_dpp v105, v106, v105 wave_shr:1 row_mask:0xf bank_mask:0xf bound_ctrl:0
    v_add_f32_dpp v109, v110, v109 wave_shr:1 row_mask:0xf bank_mask:0xf bound_ctrl:0
    v_mfma_f32_16x16x32_bf16 v[116:119], v[24:27], v[172:175], v[116:119]
    ds_read_b64_tr_b16 v[62:63], v12 offset:2816
    v_mfma_f32_16x16x32_bf16 v[116:119], v[28:31], v[168:171], v[116:119]
    s_waitcnt lgkmcnt(12)
    v_fmac_f32 v104, v2, v230
    v_fmac_f32 v108, v2, v231
    v_mfma_f32_16x16x32_bf16 v[116:119], v[32:35], v[164:167], v[116:119]
    v_add_f32_dpp v104, v105, v104 wave_shr:1 row_mask:0xf bank_mask:0xf bound_ctrl:0
    v_add_f32_dpp v108, v109, v108 wave_shr:1 row_mask:0xf bank_mask:0xf bound_ctrl:0
    v_mfma_f32_16x16x32_bf16 v[116:119], v[36:39], v[160:163], v[116:119]
    s_mov_b64 exec, s[58:59]
    ds_write2_b32 v15, v214, v215 offset0:48 offset1:56
    s_mov_b64 exec, -1
    v_mfma_f32_16x16x32_bf16 v[116:119], v[40:43], v[156:159], v[116:119]
    ds_write2st64_b32 v14, v104, v108 offset0:12 offset1:14
    v_mfma_f32_16x16x32_bf16 v[116:119], v[44:47], v[152:155], v[116:119]
    s_mov_b64 exec, s[58:59]
    ds_add_u32 v10, v11
    s_mov_b64 exec, -1
    v_mfma_f32_16x16x32_bf16 v[116:119], v[48:51], v[148:151], v[116:119]
    ds_read_b64_tr_b16 v[64:65], v12 offset:3104
    s_waitcnt lgkmcnt(14)
    v_mfma_f32_16x16x32_bf16 v[116:119], v[52:55], v[144:147], v[116:119]
    ds_read_b64_tr_b16 v[66:67], v12 offset:3072
    v_mfma_f32_16x16x32_bf16 v[120:123], v[16:19], v[184:187], 0
    ds_read_u16_d16_hi v234, v3 offset:2560
    v_mfma_f32_16x16x32_bf16 v[120:123], v[20:23], v[180:183], v[120:123]
    ds_read_u16_d16_hi v235, v3 offset:2816
    v_mfma_f32_16x16x32_bf16 v[120:123], v[24:27], v[176:179], v[120:123]
    ds_read_b64_tr_b16 v[68:69], v12 offset:3360
    v_mfma_f32_16x16x32_bf16 v[120:123], v[28:31], v[172:175], v[120:123]
    ds_read_b64_tr_b16 v[70:71], v12 offset:3328
    v_mfma_f32_16x16x32_bf16 v[120:123], v[32:35], v[168:171], v[120:123]
    ds_read_u16_d16_hi v236, v3 offset:3072
    v_mfma_f32_16x16x32_bf16 v[120:123], v[36:39], v[164:167], v[120:123]
    ds_read_u16_d16_hi v237, v3 offset:3328
    v_mfma_f32_16x16x32_bf16 v[120:123], v[40:43], v[160:163], v[120:123]
    ds_read_b64_tr_b16 v[72:73], v12 offset:3616
    v_mfma_f32_16x16x32_bf16 v[120:123], v[44:47], v[156:159], v[120:123]
    v_add_f32_dpp v216, v113, v114 wave_shl:1 row_mask:0xf bank_mask:0xf bound_ctrl:0
    v_add_f32_dpp v217, v117, v118 wave_shl:1 row_mask:0xf bank_mask:0xf bound_ctrl:0
    v_mfma_f32_16x16x32_bf16 v[120:123], v[48:51], v[152:155], v[120:123]
    v_add_f32_dpp v114, v115, v114 wave_shr:1 row_mask:0xf bank_mask:0xf bound_ctrl:0
    v_add_f32_dpp v118, v119, v118 wave_shr:1 row_mask:0xf bank_mask:0xf bound_ctrl:0
    v_mfma_f32_16x16x32_bf16 v[120:123], v[52:55], v[148:151], v[120:123]
    v_add_f32_dpp v216, v216, v115 wave_shl:1 row_mask:0xf bank_mask:0xf bound_ctrl:0
    v_add_f32_dpp v217, v217, v119 wave_shl:1 row_mask:0xf bank_mask:0xf bound_ctrl:0
    s_waitcnt lgkmcnt(15)
    v_mfma_f32_16x16x32_bf16 v[120:123], v[56:59], v[144:147], v[120:123]
    v_add_f32_dpp v113, v114, v113 wave_shr:1 row_mask:0xf bank_mask:0xf bound_ctrl:0
    v_add_f32_dpp v117, v118, v117 wave_shr:1 row_mask:0xf bank_mask:0xf bound_ctrl:0
    v_mfma_f32_16x16x32_bf16 v[124:127], v[16:19], v[188:191], 0
    v_fmac_f32 v112, v2, v232
    v_fmac_f32 v116, v2, v233
    v_mfma_f32_16x16x32_bf16 v[124:127], v[20:23], v[184:187], v[124:127]
    v_add_f32_dpp v112, v113, v112 wave_shr:1 row_mask:0xf bank_mask:0xf bound_ctrl:0
    v_add_f32_dpp v116, v117, v116 wave_shr:1 row_mask:0xf bank_mask:0xf bound_ctrl:0
    v_mfma_f32_16x16x32_bf16 v[124:127], v[24:27], v[180:183], v[124:127]
    ds_read_b64_tr_b16 v[74:75], v12 offset:3584
    v_mfma_f32_16x16x32_bf16 v[124:127], v[28:31], v[176:179], v[124:127]
    ds_read_b64_tr_b16 v[76:77], v12 offset:3872
    v_mfma_f32_16x16x32_bf16 v[124:127], v[32:35], v[172:175], v[124:127]
    ds_read_b64_tr_b16 v[78:79], v12 offset:3840
    v_mfma_f32_16x16x32_bf16 v[124:127], v[36:39], v[168:171], v[124:127]
    ds_read_u16_d16_hi v238, v3 offset:3584
    v_mfma_f32_16x16x32_bf16 v[124:127], v[40:43], v[164:167], v[124:127]
    ds_read_u16_d16_hi v239, v3 offset:3840
    v_mfma_f32_16x16x32_bf16 v[124:127], v[44:47], v[160:163], v[124:127]
    v_mfma_f32_16x16x32_bf16 v[124:127], v[48:51], v[156:159], v[124:127]
    v_mfma_f32_16x16x32_bf16 v[124:127], v[52:55], v[152:155], v[124:127]
    v_mfma_f32_16x16x32_bf16 v[124:127], v[56:59], v[148:151], v[124:127]
    s_waitcnt lgkmcnt(15)
    v_mfma_f32_16x16x32_bf16 v[124:127], v[60:63], v[144:147], v[124:127]
    v_mfma_f32_16x16x32_bf16 v[128:131], v[16:19], v[192:195], 0
    v_mfma_f32_16x16x32_bf16 v[128:131], v[20:23], v[188:191], v[128:131]
    v_mfma_f32_16x16x32_bf16 v[128:131], v[24:27], v[184:187], v[128:131]
    v_mfma_f32_16x16x32_bf16 v[128:131], v[28:31], v[180:183], v[128:131]
    v_mfma_f32_16x16x32_bf16 v[128:131], v[32:35], v[176:179], v[128:131]
    v_mfma_f32_16x16x32_bf16 v[128:131], v[36:39], v[172:175], v[128:131]
    v_mfma_f32_16x16x32_bf16 v[128:131], v[40:43], v[168:171], v[128:131]
    v_mfma_f32_16x16x32_bf16 v[128:131], v[44:47], v[164:167], v[128:131]
    v_add_f32_dpp v218, v121, v122 wave_shl:1 row_mask:0xf bank_mask:0xf bound_ctrl:0
    v_add_f32_dpp v219, v125, v126 wave_shl:1 row_mask:0xf bank_mask:0xf bound_ctrl:0
    v_mfma_f32_16x16x32_bf16 v[128:131], v[48:51], v[160:163], v[128:131]
    v_add_f32_dpp v122, v123, v122 wave_shr:1 row_mask:0xf bank_mask:0xf bound_ctrl:0
    v_add_f32_dpp v126, v127, v126 wave_shr:1 row_mask:0xf bank_mask:0xf bound_ctrl:0
    v_mfma_f32_16x16x32_bf16 v[128:131], v[52:55], v[156:159], v[128:131]
    v_add_f32_dpp v218, v218, v123 wave_shl:1 row_mask:0xf bank_mask:0xf bound_ctrl:0
    v_add_f32_dpp v219, v219, v127 wave_shl:1 row_mask:0xf bank_mask:0xf bound_ctrl:0
    v_mfma_f32_16x16x32_bf16 v[128:131], v[56:59], v[152:155], v[128:131]
    v_add_f32_dpp v121, v122, v121 wave_shr:1 row_mask:0xf bank_mask:0xf bound_ctrl:0
    v_add_f32_dpp v125, v126, v125 wave_shr:1 row_mask:0xf bank_mask:0xf bound_ctrl:0
    v_mfma_f32_16x16x32_bf16 v[128:131], v[60:63], v[148:151], v[128:131]
    s_waitcnt lgkmcnt(10)
    v_fmac_f32 v120, v2, v234
    v_fmac_f32 v124, v2, v235
    v_mfma_f32_16x16x32_bf16 v[128:131], v[64:67], v[144:147], v[128:131]
    v_add_f32_dpp v120, v121, v120 wave_shr:1 row_mask:0xf bank_mask:0xf bound_ctrl:0
    v_add_f32_dpp v124, v125, v124 wave_shr:1 row_mask:0xf bank_mask:0xf bound_ctrl:0
    v_mfma_f32_16x16x32_bf16 v[132:135], v[16:19], v[196:199], 0
    v_mfma_f32_16x16x32_bf16 v[132:135], v[20:23], v[192:195], v[132:135]
    v_mfma_f32_16x16x32_bf16 v[132:135], v[24:27], v[188:191], v[132:135]
    v_mfma_f32_16x16x32_bf16 v[132:135], v[28:31], v[184:187], v[132:135]
    v_mfma_f32_16x16x32_bf16 v[132:135], v[32:35], v[180:183], v[132:135]
    v_mfma_f32_16x16x32_bf16 v[132:135], v[36:39], v[176:179], v[132:135]
    v_mfma_f32_16x16x32_bf16 v[132:135], v[40:43], v[172:175], v[132:135]
    v_mfma_f32_16x16x32_bf16 v[132:135], v[44:47], v[168:171], v[132:135]
    v_mfma_f32_16x16x32_bf16 v[132:135], v[48:51], v[164:167], v[132:135]
    v_mfma_f32_16x16x32_bf16 v[132:135], v[52:55], v[160:163], v[132:135]
    v_mfma_f32_16x16x32_bf16 v[132:135], v[56:59], v[156:159], v[132:135]
    v_mfma_f32_16x16x32_bf16 v[132:135], v[60:63], v[152:155], v[132:135]
    v_mfma_f32_16x16x32_bf16 v[132:135], v[64:67], v[148:151], v[132:135]
    s_waitcnt lgkmcnt(8)
    v_mfma_f32_16x16x32_bf16 v[132:135], v[68:71], v[144:147], v[132:135]
    v_mfma_f32_16x16x32_bf16 v[136:139], v[16:19], v[200:203], 0
    v_mfma_f32_16x16x32_bf16 v[136:139], v[20:23], v[196:199], v[136:139]
    v_mfma_f32_16x16x32_bf16 v[136:139], v[24:27], v[192:195], v[136:139]
    v_mfma_f32_16x16x32_bf16 v[136:139], v[28:31], v[188:191], v[136:139]
    v_mfma_f32_16x16x32_bf16 v[136:139], v[32:35], v[184:187], v[136:139]
    v_mfma_f32_16x16x32_bf16 v[136:139], v[36:39], v[180:183], v[136:139]
    v_mfma_f32_16x16x32_bf16 v[136:139], v[40:43], v[176:179], v[136:139]
    v_mfma_f32_16x16x32_bf16 v[136:139], v[44:47], v[172:175], v[136:139]
    v_add_f32_dpp v220, v129, v130 wave_shl:1 row_mask:0xf bank_mask:0xf bound_ctrl:0
    v_add_f32_dpp v221, v133, v134 wave_shl:1 row_mask:0xf bank_mask:0xf bound_ctrl:0
    v_mfma_f32_16x16x32_bf16 v[136:139], v[48:51], v[168:171], v[136:139]
    v_add_f32_dpp v130, v131, v130 wave_shr:1 row_mask:0xf bank_mask:0xf bound_ctrl:0
    v_add_f32_dpp v134, v135, v134 wave_shr:1 row_mask:0xf bank_mask:0xf bound_ctrl:0
    v_mfma_f32_16x16x32_bf16 v[136:139], v[52:55], v[164:167], v[136:139]
    v_add_f32_dpp v220, v220, v131 wave_shl:1 row_mask:0xf bank_mask:0xf bound_ctrl:0
    v_add_f32_dpp v221, v221, v135 wave_shl:1 row_mask:0xf bank_mask:0xf bound_ctrl:0
    v_mfma_f32_16x16x32_bf16 v[136:139], v[56:59], v[160:163], v[136:139]
    v_add_f32_dpp v129, v130, v129 wave_shr:1 row_mask:0xf bank_mask:0xf bound_ctrl:0
    v_add_f32_dpp v133, v134, v133 wave_shr:1 row_mask:0xf bank_mask:0xf bound_ctrl:0
    v_mfma_f32_16x16x32_bf16 v[136:139], v[60:63], v[156:159], v[136:139]
    s_waitcnt lgkmcnt(6)
    v_fmac_f32 v128, v2, v236
    v_fmac_f32 v132, v2, v237
    v_mfma_f32_16x16x32_bf16 v[136:139], v[64:67], v[152:155], v[136:139]
    v_add_f32_dpp v128, v129, v128 wave_shr:1 row_mask:0xf bank_mask:0xf bound_ctrl:0
    v_add_f32_dpp v132, v133, v132 wave_shr:1 row_mask:0xf bank_mask:0xf bound_ctrl:0
    v_mfma_f32_16x16x32_bf16 v[136:139], v[68:71], v[148:151], v[136:139]
    s_waitcnt lgkmcnt(4)
    v_mfma_f32_16x16x32_bf16 v[136:139], v[72:75], v[144:147], v[136:139]
    v_mfma_f32_16x16x32_bf16 v[140:143], v[16:19], v[204:207], 0
    v_mfma_f32_16x16x32_bf16 v[140:143], v[20:23], v[200:203], v[140:143]
    v_mfma_f32_16x16x32_bf16 v[140:143], v[24:27], v[196:199], v[140:143]
    v_mfma_f32_16x16x32_bf16 v[140:143], v[28:31], v[192:195], v[140:143]
    v_mfma_f32_16x16x32_bf16 v[140:143], v[32:35], v[188:191], v[140:143]
    v_mfma_f32_16x16x32_bf16 v[140:143], v[36:39], v[184:187], v[140:143]
    v_mfma_f32_16x16x32_bf16 v[140:143], v[40:43], v[180:183], v[140:143]
    v_mfma_f32_16x16x32_bf16 v[140:143], v[44:47], v[176:179], v[140:143]
    v_mfma_f32_16x16x32_bf16 v[140:143], v[48:51], v[172:175], v[140:143]
    v_mfma_f32_16x16x32_bf16 v[140:143], v[52:55], v[168:171], v[140:143]
    v_mfma_f32_16x16x32_bf16 v[140:143], v[56:59], v[164:167], v[140:143]
    v_mfma_f32_16x16x32_bf16 v[140:143], v[60:63], v[160:163], v[140:143]
    v_mfma_f32_16x16x32_bf16 v[140:143], v[64:67], v[156:159], v[140:143]
    v_mfma_f32_16x16x32_bf16 v[140:143], v[68:71], v[152:155], v[140:143]
    v_mfma_f32_16x16x32_bf16 v[140:143], v[72:75], v[148:151], v[140:143]
    s_waitcnt lgkmcnt(2)
    v_mfma_f32_16x16x32_bf16 v[140:143], v[76:79], v[144:147], v[140:143]
    s_nop 7
    v_add_f32_dpp v222, v137, v138 wave_shl:1 row_mask:0xf bank_mask:0xf bound_ctrl:0
    v_add_f32_dpp v223, v141, v142 wave_shl:1 row_mask:0xf bank_mask:0xf bound_ctrl:0
    v_add_f32_dpp v138, v139, v138 wave_shr:1 row_mask:0xf bank_mask:0xf bound_ctrl:0
    v_add_f32_dpp v142, v143, v142 wave_shr:1 row_mask:0xf bank_mask:0xf bound_ctrl:0
    v_add_f32_dpp v222, v222, v139 wave_shl:1 row_mask:0xf bank_mask:0xf bound_ctrl:0
    v_add_f32_dpp v223, v223, v143 wave_shl:1 row_mask:0xf bank_mask:0xf bound_ctrl:0
    v_add_f32_dpp v137, v138, v137 wave_shr:1 row_mask:0xf bank_mask:0xf bound_ctrl:0
    v_add_f32_dpp v141, v142, v141 wave_shr:1 row_mask:0xf bank_mask:0xf bound_ctrl:0
    s_waitcnt lgkmcnt(0)
    v_fmac_f32 v136, v2, v238
    v_fmac_f32 v140, v2, v239
    v_add_f32_dpp v136, v137, v136 wave_shr:1 row_mask:0xf bank_mask:0xf bound_ctrl:0
    v_add_f32_dpp v140, v141, v140 wave_shr:1 row_mask:0xf bank_mask:0xf bound_ctrl:0
    s_mov_b64 exec, s[58:59]
    ds_write2_b32 v15, v216, v217 offset0:64 offset1:72
    s_mov_b64 exec, -1
    ds_write2st64_b32 v14, v112, v116 offset0:16 offset1:18
    s_mov_b64 exec, s[58:59]
    ds_write2_b32 v15, v218, v219 offset0:80 offset1:88
    s_mov_b64 exec, -1
    ds_write2st64_b32 v14, v120, v124 offset0:20 offset1:22
    s_mov_b64 exec, s[58:59]
    ds_write2_b32 v15, v220, v221 offset0:96 offset1:104
    s_mov_b64 exec, -1
    ds_write2st64_b32 v14, v128, v132 offset0:24 offset1:26
    s_mov_b64 exec, s[58:59]
    ds_write2_b32 v15, v222, v223 offset0:112 offset1:120
    s_mov_b64 exec, -1
    ds_write2st64_b32 v14, v136, v140 offset0:28 offset1:30
    s_setprio 0
    s_waitcnt lgkmcnt(0)
    s_barrier
    ds_read_b64_tr_b16 v[144:145], v8 offset:0
    ds_read_b64_tr_b16 v[146:147], v8 offset:1024
    ds_read_b64_tr_b16 v[148:149], v8 offset:4096
    ds_read_b64_tr_b16 v[150:151], v8 offset:5120
    ds_read_b64_tr_b16 v[152:153], v8 offset:16384
    ds_read_b64_tr_b16 v[154:155], v8 offset:17408
    ds_read_b64_tr_b16 v[156:157], v8 offset:20480
    ds_read_b64_tr_b16 v[158:159], v8 offset:21504
    ds_read_b64_tr_b16 v[160:161], v8 offset:32768
    ds_read_b64_tr_b16 v[162:163], v8 offset:33792
    ds_read_b64_tr_b16 v[164:165], v8 offset:36864
    ds_read_b64_tr_b16 v[166:167], v8 offset:37888
    ds_read_b64_tr_b16 v[168:169], v8 offset:49152
    ds_read_b64_tr_b16 v[170:171], v8 offset:50176
    ds_read_b64_tr_b16 v[172:173], v8 offset:53248
    ds_read_b64_tr_b16 v[174:175], v8 offset:54272
    ds_read_b64_tr_b16 v[176:177], v9 offset:0
    ds_read_b64_tr_b16 v[178:179], v9 offset:1024
    ds_read_b64_tr_b16 v[180:181], v9 offset:4096
    ds_read_b64_tr_b16 v[182:183], v9 offset:5120
    ds_read_b64_tr_b16 v[184:185], v9 offset:16384
    ds_read_b64_tr_b16 v[186:187], v9 offset:17408
    ds_read_b64_tr_b16 v[188:189], v9 offset:20480
    ds_read_b64_tr_b16 v[190:191], v9 offset:21504
    ds_read_b64_tr_b16 v[192:193], v9 offset:32768
    ds_read_b64_tr_b16 v[194:195], v9 offset:33792
    ds_read_b64_tr_b16 v[196:197], v9 offset:36864
    ds_read_b64_tr_b16 v[198:199], v9 offset:37888
    ds_read_b64_tr_b16 v[200:201], v9 offset:49152
    ds_read_b64_tr_b16 v[202:203], v9 offset:50176
    ds_read_b64_tr_b16 v[204:205], v9 offset:53248
    ds_read_b64_tr_b16 v[206:207], v9 offset:54272
    s_waitcnt lgkmcnt(0)
    s_barrier
    s_branch fj_2
fx_1:
    s_waitcnt vmcnt(2)
    s_barrier
    s_cmp_ge_u32 s48, 6
    s_cbranch_scc1 ld_11
    s_lshl_b32 s53, s51, 10
    s_add_u32 s57, s53, 147712
    v_add_u32 v12, s57, v13
    s_lshl_b32 s56, s95, 16
    s_and_b32 s58, s95, 0xffff0000
    v_mov_b32 v32, s56
    v_mov_b32 v33, s58
    v_mov_b32 v34, 0xffff0000
    s_lshl_b32 s56, s51, 11
    s_add_u32 s56, s56, 131072
    v_lshl_add_u32 v14, v0, 5, s56
    v_lshrrev_b32 v5, 3, v0
    s_lshl_b32 s56, s51, 7
    s_add_u32 s56, s56, 156160
    v_lshl_add_u32 v15, v5, 4, s56
    s_mov_b32 s56, 57344
    v_mul_lo_u32 v5, v5, s56
    v_and_b32 v6, 7, v0
    v_lshl_add_u32 v35, v6, 4, v5
    s_lshl_b32 s55, s2, 8
    s_mul_i32 s56, s51, 458752
    s_add_u32 s55, s55, s56
    s_add_u32 s55, s55, 4194304
    s_lshl_b32 s52, s2, 13
    s_add_u32 s52, s52, s53
    s_add_u32 s52, s52, 2097152
    s_add_u32 s54, s52, 4096
    s_lshl_b32 s62, s51, 12
    s_add_u32 s62, s62, 1835008
    s_add_u32 s61, s62, 8192
    s_lshl_b32 s60, s2, 5
    s_lshl2_add_u32 s60, s51, s60
    s_add_u32 s60, s60, 3932160
    s_barrier
    s_barrier
    buffer_load_dwordx4 v[224:227], v13, s[40:43], s62 offen offset:0 sc1
    buffer_load_dwordx4 v[228:231], v13, s[40:43], s62 offen offset:1024 sc1
    buffer_load_dwordx4 v[232:235], v13, s[40:43], s62 offen offset:2048 sc1
    buffer_load_dwordx4 v[236:239], v13, s[40:43], s62 offen offset:3072 sc1
    buffer_load_dwordx4 v[240:243], v13, s[40:43], s61 offen offset:0 sc1
    buffer_load_dwordx4 v[244:247], v13, s[40:43], s61 offen offset:1024 sc1
    buffer_load_dwordx4 v[248:251], v13, s[40:43], s61 offen offset:2048 sc1
    buffer_load_dwordx4 v[252:255], v13, s[40:43], s61 offen offset:3072 sc1
    buffer_load_dwordx4 v[16:19], v13, s[40:43], s52 offen offset:0 sc1
    buffer_load_dwordx4 v[20:23], v13, s[40:43], s52 offen offset:2048 sc1
    buffer_load_dwordx4 v[24:27], v13, s[40:43], s54 offen offset:0 sc1
    buffer_load_dwordx4 v[28:31], v13, s[40:43], s54 offen offset:2048 sc1
    s_barrier
    s_mov_b32 s57, 0
    s_waitcnt vmcnt(4)
sf_12:
    v_cmpx_eq_u32 vcc, s3, v225
    v_cmpx_eq_u32 vcc, s3, v227
    v_cmpx_eq_u32 vcc, s3, v229
    v_cmpx_eq_u32 vcc, s3, v231
    v_cmpx_eq_u32 vcc, s3, v233
    v_cmpx_eq_u32 vcc, s3, v235
    v_cmpx_eq_u32 vcc, s3, v237
    v_cmpx_eq_u32 vcc, s3, v239
    v_cmpx_eq_u32 vcc, s3, v241
    v_cmpx_eq_u32 vcc, s3, v243
    v_cmpx_eq_u32 vcc, s3, v245
    v_cmpx_eq_u32 vcc, s3, v247
    v_cmpx_eq_u32 vcc, s3, v249
    v_cmpx_eq_u32 vcc, s3, v251
    v_cmpx_eq_u32 vcc, s3, v253
    v_cmpx_eq_u32 vcc, s3, v255
    s_nop 4
    s_cmp_eq_u64 exec, -1
    s_mov_b64 exec, -1
    s_cbranch_scc1 sf_12d
    s_add_u32 s57, s57, 1
    s_cmp_gt_u32 s57, 0x40000
    s_cbranch_scc1 sf_12d
    buffer_load_dwordx4 v[224:227], v13, s[40:43], s62 offen offset:0 sc1
    buffer_load_dwordx4 v[228:231], v13, s[40:43], s62 offen offset:1024 sc1
    buffer_load_dwordx4 v[232:235], v13, s[40:43], s62 offen offset:2048 sc1
    buffer_load_dwordx4 v[236:239], v13, s[40:43], s62 offen offset:3072 sc1
    buffer_load_dwordx4 v[240:243], v13, s[40:43], s61 offen offset:0 sc1
    buffer_load_dwordx4 v[244:247], v13, s[40:43], s61 offen offset:1024 sc1
    buffer_load_dwordx4 v[248:251], v13, s[40:43], s61 offen offset:2048 sc1
    buffer_load_dwordx4 v[252:255], v13, s[40:43], s61 offen offset:3072 sc1
    s_waitcnt vmcnt(0)
    s_branch sf_12
sf_12d:
    s_setprio 3
    v_and_b32 v36, v34, v224
    v_lshlrev_b32 v208, 16, v224
    v_and_b32 v37, v34, v226
    v_lshlrev_b32 v209, 16, v226
    v_and_b32 v38, v34, v228
    v_lshlrev_b32 v210, 16, v228
    v_and_b32 v39, v34, v230
    v_lshlrev_b32 v211, 16, v230
    v_and_b32 v40, v34, v232
    v_lshlrev_b32 v212, 16, v232
    v_and_b32 v41, v34, v234
    v_lshlrev_b32 v213, 16, v234
    v_and_b32 v42, v34, v236
    v_lshlrev_b32 v214, 16, v236
    v_and_b32 v43, v34, v238
    v_lshlrev_b32 v215, 16, v238
    v_and_b32 v44, v34, v240
    v_lshlrev_b32 v216, 16, v240
    v_and_b32 v45, v34, v242
    v_lshlrev_b32 v217, 16, v242
    v_and_b32 v46, v34, v244
    v_lshlrev_b32 v218, 16, v244
    v_and_b32 v47, v34, v246
    v_lshlrev_b32 v219, 16, v246
    v_and_b32 v48, v34, v248
    v_lshlrev_b32 v220, 16, v248
    v_and_b32 v49, v34, v250
    v_lshlrev_b32 v221, 16, v250
    v_and_b32 v50, v34, v252
    v_lshlrev_b32 v222, 16, v252
    v_and_b32 v51, v34, v254
    v_lshlrev_b32 v223, 16, v254
    v_rcp_f32 v36, v36
    v_rcp_f32 v37, v37
    v_rcp_f32 v38, v38
    v_rcp_f32 v39, v39
    v_rcp_f32 v40, v40
    v_rcp_f32 v41, v41
    v_rcp_f32 v42, v42
    v_rcp_f32 v43, v43
    v_rcp_f32 v44, v44
    v_rcp_f32 v45, v45
    v_rcp_f32 v46, v46
    v_rcp_f32 v47, v47
    v_rcp_f32 v48, v48
    v_rcp_f32 v49, v49
    v_rcp_f32 v50, v50
    v_rcp_f32 v51, v51
    v_mul_f32 v208, v208, v36
    v_mul_f32 v209, v209, v37
    v_mul_f32 v210, v210, v38
    v_mul_f32 v211, v211, v39
    v_mul_f32 v212, v212, v40
    v_mul_f32 v213, v213, v41
    v_mul_f32 v214, v214, v42
    v_mul_f32 v215, v215, v43
    v_mul_f32 v216, v216, v44
    v_mul_f32 v217, v217, v45
    v_mul_f32 v218, v218, v46
    v_mul_f32 v219, v219, v47
    v_mul_f32 v220, v220, v48
    v_mul_f32 v221, v221, v49
    v_mul_f32 v222, v222, v50
    v_mul_f32 v223, v223, v51
    s_mov_b32 s58, 0x01010101
    s_mov_b32 s59, 0x01010101
    v_mov_b32 v10, 163784
    s_setprio 3
    s_waitcnt vmcnt(0)
    v_lshlrev_b32 v112, 16, v16
    v_and_b32 v113, v34, v16
    v_lshlrev_b32 v114, 16, v17
    v_and_b32 v115, v34, v17
    v_lshlrev_b32 v116, 16, v18
    v_and_b32 v117, v34, v18
    v_lshlrev_b32 v118, 16, v19
    v_and_b32 v119, v34, v19
    v_lshlrev_b32 v128, 16, v24
    v_and_b32 v129, v34, v24
    v_lshlrev_b32 v130, 16, v25
    v_and_b32 v131, v34, v25
    v_lshlrev_b32 v132, 16, v26
    v_and_b32 v133, v34, v26
    v_lshlrev_b32 v134, 16, v27
    v_and_b32 v135, v34, v27
    v_fma_f32 v64, v112, v36, v208
    v_fma_f32 v65, v113, v37, v209
    v_fma_f32 v66, v114, v38, v210
    v_fma_f32 v67, v115, v39, v211
    v_fma_f32 v68, v116, v40, v212
    v_fma_f32 v69, v117, v41, v213
    v_fma_f32 v70, v118, v42, v214
    v_fma_f32 v71, v119, v43, v215
    v_fma_f32 v80, v128, v36, v208
    v_fma_f32 v81, v129, v37, v209
    v_fma_f32 v82, v130, v38, v210
    v_fma_f32 v83, v131, v39, v211
    v_fma_f32 v84, v132, v40, v212
    v_fma_f32 v85, v133, v41, v213
    v_fma_f32 v86, v134, v42, v214
    v_fma_f32 v87, v135, v43, v215
    s_mov_b32 s57, 0
spin_13:
    s_sleep 1
    ds_read_b32 v11, v10
    s_add_u32 s57, s57, 1
    s_cmp_gt_u32 s57, 0x100000
    s_cbranch_scc1 spin_14
    s_waitcnt lgkmcnt(0)
    v_cmp_gt_u32 vcc, 12, v11
    s_cbranch_vccnz spin_13
spin_14:
    ds_read_b128 v[224:227], v14 offset:0
    ds_read_b128 v[228:231], v14 offset:16
    ds_read_b128 v[96:99], v15 offset:0
    ds_read_b128 v[240:243], v14 offset:8192
    ds_read_b128 v[244:247], v14 offset:8208
    ds_read_b128 v[104:107], v15 offset:640
    s_waitcnt lgkmcnt(3)
    s_mov_b64 exec, s[58:59]
    v_add_f32 v224, v224, v97
    v_add_f32 v225, v225, v98
    v_add_f32 v226, v226, v99
    s_mov_b64 exec, -1
    v_fmac_f32 v115, v67, v227
    v_fmac_f32 v116, v68, v228
    v_fmac_f32 v117, v69, v229
    v_fmac_f32 v118, v70, v230
    v_fmac_f32 v119, v71, v231
    v_fmac_f32 v112, v64, v224
    v_fmac_f32 v113, v65, v225
    v_fmac_f32 v114, v66, v226
    v_cvt_pk_bf16_f32 v18, v116, v117
    v_cvt_pk_bf16_f32 v19, v118, v119
    v_cvt_pk_bf16_f32 v16, v112, v113
    v_cvt_pk_bf16_f32 v17, v114, v115
    s_add_u32 s56, s55, 0
    buffer_store_dwordx4 v[16:19], v35, s[40:43], s56 offen sc1
    s_waitcnt lgkmcnt(0)
    s_mov_b64 exec, s[58:59]
    v_add_f32 v240, v240, v105
    v_add_f32 v241, v241, v106
    v_add_f32 v242, v242, v107
    s_mov_b64 exec, -1
    v_fmac_f32 v131, v83, v243
    v_fmac_f32 v132, v84, v244
    v_fmac_f32 v133, v85, v245
    v_fmac_f32 v134, v86, v246
    v_fmac_f32 v135, v87, v247
    v_fmac_f32 v128, v80, v240
    v_fmac_f32 v129, v81, v241
    v_fmac_f32 v130, v82, v242
    v_cvt_pk_bf16_f32 v26, v132, v133
    v_cvt_pk_bf16_f32 v27, v134, v135
    v_cvt_pk_bf16_f32 v24, v128, v129
    v_cvt_pk_bf16_f32 v25, v130, v131
    s_add_u32 s56, s55, 128
    buffer_store_dwordx4 v[24:27], v35, s[40:43], s56 offen sc1
    v_mov_b32 v11, 1
    s_mov_b64 exec, 1
    ds_add_u32 v10, v11
    s_mov_b64 exec, -1
    s_setprio 0
    v_lshlrev_b32 v120, 16, v20
    v_and_b32 v121, v34, v20
    v_lshlrev_b32 v122, 16, v21
    v_and_b32 v123, v34, v21
    v_lshlrev_b32 v124, 16, v22
    v_and_b32 v125, v34, v22
    v_lshlrev_b32 v126, 16, v23
    v_and_b32 v127, v34, v23
    v_lshlrev_b32 v136, 16, v28
    v_and_b32 v137, v34, v28
    v_lshlrev_b32 v138, 16, v29
    v_and_b32 v139, v34, v29
    v_lshlrev_b32 v140, 16, v30
    v_and_b32 v141, v34, v30
    v_lshlrev_b32 v142, 16, v31
    v_and_b32 v143, v34, v31
    v_fma_f32 v72, v120, v44, v216
    v_fma_f32 v73, v121, v45, v217
    v_fma_f32 v74, v122, v46, v218
    v_fma_f32 v75, v123, v47, v219
    v_fma_f32 v76, v124, v48, v220
    v_fma_f32 v77, v125, v49, v221
    v_fma_f32 v78, v126, v50, v222
    v_fma_f32 v79, v127, v51, v223
    v_fma_f32 v88, v136, v44, v216
    v_fma_f32 v89, v137, v45, v217
    v_fma_f32 v90, v138, v46, v218
    v_fma_f32 v91, v139, v47, v219
    v_fma_f32 v92, v140, v48, v220
    v_fma_f32 v93, v141, v49, v221
    v_fma_f32 v94, v142, v50, v222
    v_fma_f32 v95, v143, v51, v223
    v_bfe_u32 v4, v0, 4, 1
    v_lshrrev_b32 v5, 5, v0
    v_bfe_u32 v6, v0, 2, 2
    v_and_b32 v7, 3, v0
    v_lshl_add_u32 v8, v6, 1, v4
    v_xor_b32 v8, s48, v8
    v_lshlrev_b32 v8, 5, v8
    v_lshl_add_u32 v8, v7, 3, v8
    v_lshl_add_u32 v5, v5, 3, v6
    v_lshl_add_u32 v8, v5, 8, v8
    v_lshl_add_u32 v8, v4, 13, v8
    v_add_u32 v9, 0x10000, v8
    s_waitcnt vmcnt(0)
    v_mov_b32 v2, s3
    v_lshlrev_b32 v4, 13, v0
    s_mov_b64 exec, 0xff
    buffer_store_dword v2, v4, s[40:43], s60 offen sc1
    s_mov_b64 exec, -1
    s_add_u32 s60, s60, 65536
    s_setprio 2
    s_barrier
    ds_read_b128 v[232:235], v14 offset:4096
    ds_read_b128 v[236:239], v14 offset:4112
    ds_read_b128 v[100:103], v15 offset:256
    ds_read_b128 v[248:251], v14 offset:12288
    ds_read_b128 v[252:255], v14 offset:12304
    ds_read_b128 v[108:111], v15 offset:896
    s_waitcnt lgkmcnt(3)
    s_mov_b64 exec, s[58:59]
    v_add_f32 v232, v232, v101
    v_add_f32 v233, v233, v102
    v_add_f32 v234, v234, v103
    s_mov_b64 exec, -1
    v_pk_fma_f32 v[124:125], v[76:77], v[236:237], v[124:125]
    v_pk_fma_f32 v[126:127], v[78:79], v[238:239], v[126:127]
    v_pk_fma_f32 v[120:121], v[72:73], v[232:233], v[120:121]
    v_pk_fma_f32 v[122:123], v[74:75], v[234:235], v[122:123]
    v_cvt_pk_bf16_f32 v22, v124, v125
    v_cvt_pk_bf16_f32 v23, v126, v127
    v_cvt_pk_bf16_f32 v20, v120, v121
    v_cvt_pk_bf16_f32 v21, v122, v123
    s_add_u32 s56, s55, 917504
    buffer_store_dwordx4 v[20:23], v35, s[40:43], s56 offen sc1
    s_waitcnt lgkmcnt(0)
    s_mov_b64 exec, s[58:59]
    v_add_f32 v248, v248, v109
    v_add_f32 v249, v249, v110
    v_add_f32 v250, v250, v111
    s_mov_b64 exec, -1
    v_pk_fma_f32 v[140:141], v[92:93], v[252:253], v[140:141]
    v_pk_fma_f32 v[142:143], v[94:95], v[254:255], v[142:143]
    v_pk_fma_f32 v[136:137], v[88:89], v[248:249], v[136:137]
    v_pk_fma_f32 v[138:139], v[90:91], v[250:251], v[138:139]
    v_cvt_pk_bf16_f32 v30, v140, v141
    v_cvt_pk_bf16_f32 v31, v142, v143
    v_cvt_pk_bf16_f32 v28, v136, v137
    v_cvt_pk_bf16_f32 v29, v138, v139
    s_add_u32 s56, s55, 917632
    buffer_store_dwordx4 v[28:31], v35, s[40:43], s56 offen sc1
    ds_read_b64_tr_b16 v[144:145], v8 offset:0
    ds_read_b64_tr_b16 v[146:147], v8 offset:1024
    ds_read_b64_tr_b16 v[148:149], v8 offset:4096
    ds_read_b64_tr_b16 v[150:151], v8 offset:5120
    ds_read_b64_tr_b16 v[152:153], v8 offset:16384
    ds_read_b64_tr_b16 v[154:155], v8 offset:17408
    ds_read_b64_tr_b16 v[156:157], v8 offset:20480
    ds_read_b64_tr_b16 v[158:159], v8 offset:21504
    ds_read_b64_tr_b16 v[160:161], v8 offset:32768
    ds_read_b64_tr_b16 v[162:163], v8 offset:33792
    ds_read_b64_tr_b16 v[164:165], v8 offset:36864
    ds_read_b64_tr_b16 v[166:167], v8 offset:37888
    ds_read_b64_tr_b16 v[168:169], v8 offset:49152
    ds_read_b64_tr_b16 v[170:171], v8 offset:50176
    ds_read_b64_tr_b16 v[172:173], v8 offset:53248
    ds_read_b64_tr_b16 v[174:175], v8 offset:54272
    ds_read_b64_tr_b16 v[176:177], v9 offset:0
    ds_read_b64_tr_b16 v[178:179], v9 offset:1024
    ds_read_b64_tr_b16 v[180:181], v9 offset:4096
    ds_read_b64_tr_b16 v[182:183], v9 offset:5120
    ds_read_b64_tr_b16 v[184:185], v9 offset:16384
    ds_read_b64_tr_b16 v[186:187], v9 offset:17408
    ds_read_b64_tr_b16 v[188:189], v9 offset:20480
    ds_read_b64_tr_b16 v[190:191], v9 offset:21504
    ds_read_b64_tr_b16 v[192:193], v9 offset:32768
    ds_read_b64_tr_b16 v[194:195], v9 offset:33792
    ds_read_b64_tr_b16 v[196:197], v9 offset:36864
    ds_read_b64_tr_b16 v[198:199], v9 offset:37888
    ds_read_b64_tr_b16 v[200:201], v9 offset:49152
    ds_read_b64_tr_b16 v[202:203], v9 offset:50176
    ds_read_b64_tr_b16 v[204:205], v9 offset:53248
    ds_read_b64_tr_b16 v[206:207], v9 offset:54272
    s_waitcnt lgkmcnt(0)
    s_barrier
    s_waitcnt vmcnt(0)
    v_mov_b32 v2, s3
    v_lshlrev_b32 v4, 13, v0
    s_mov_b64 exec, 0xff
    buffer_store_dword v2, v4, s[40:43], s60 offen sc1
    s_mov_b64 exec, -1
    s_setprio 0
    s_branch fj_2
ld_11:
    v_lshrrev_b32 v55, 4, v0
    v_and_b32 v56, 15, v0
    v_lshlrev_b32 v57, 2, v55
    v_xor_b32 v56, v56, v57
    s_and_b32 s80, s48, 1
    s_lshl_b32 s81, s80, 1
    v_xor_b32 v56, s81, v56
    s_movk_i32 s81, 3584
    v_lshlrev_b32 v57, 4, v56
    v_mad_u32_u24 v54, v55, s81, v57
    s_lshl_b32 s80, s80, 13
    s_lshl_b32 s81, s91, 8
    s_add_u32 s81, s81, 0
    s_add_u32 m0, s80, 0
    s_add_u32 s82, s81, 0
    buffer_load_dwordx4 v54, s[44:47], s82 offen lds
    s_add_u32 m0, s80, 1024
    s_add_u32 s82, s81, 14336
    buffer_load_dwordx4 v54, s[44:47], s82 offen lds
    s_add_u32 m0, s80, 2048
    s_add_u32 s82, s81, 28672
    buffer_load_dwordx4 v54, s[44:47], s82 offen lds
    s_add_u32 m0, s80, 3072
    s_add_u32 s82, s81, 43008
    buffer_load_dwordx4 v54, s[44:47], s82 offen lds
    s_add_u32 m0, s80, 4096
    s_add_u32 s82, s81, 57344
    buffer_load_dwordx4 v54, s[44:47], s82 offen lds
    s_add_u32 m0, s80, 5120
    s_add_u32 s82, s81, 71680
    buffer_load_dwordx4 v54, s[44:47], s82 offen lds
    s_add_u32 m0, s80, 6144
    s_add_u32 s82, s81, 86016
    buffer_load_dwordx4 v54, s[44:47], s82 offen lds
    s_add_u32 m0, s80, 7168
    s_add_u32 s82, s81, 100352
    buffer_load_dwordx4 v54, s[44:47], s82 offen lds
    s_add_u32 m0, s80, 16384
    s_add_u32 s82, s81, 114688
    buffer_load_dwordx4 v54, s[44:47], s82 offen lds
    s_add_u32 m0, s80, 17408
    s_add_u32 s82, s81, 129024
    buffer_load_dwordx4 v54, s[44:47], s82 offen lds
    s_add_u32 m0, s80, 18432
    s_add_u32 s82, s81, 143360
    buffer_load_dwordx4 v54, s[44:47], s82 offen lds
    s_add_u32 m0, s80, 19456
    s_add_u32 s82, s81, 157696
    buffer_load_dwordx4 v54, s[44:47], s82 offen lds
    s_add_u32 m0, s80, 20480
    s_add_u32 s82, s81, 172032
    buffer_load_dwordx4 v54, s[44:47], s82 offen lds
    s_add_u32 m0, s80, 21504
    s_add_u32 s82, s81, 186368
    buffer_load_dwordx4 v54, s[44:47], s82 offen lds
    s_add_u32 m0, s80, 22528
    s_add_u32 s82, s81, 200704
    buffer_load_dwordx4 v54, s[44:47], s82 offen lds
    s_add_u32 m0, s80, 23552
    s_add_u32 s82, s81, 215040
    buffer_load_dwordx4 v54, s[44:47], s82 offen lds
    s_add_u32 m0, s80, 32768
    s_add_u32 s82, s81, 229376
    buffer_load_dwordx4 v54, s[44:47], s82 offen lds
    s_add_u32 m0, s80, 33792
    s_add_u32 s82, s81, 243712
    buffer_load_dwordx4 v54, s[44:47], s82 offen lds
    s_add_u32 m0, s80, 34816
    s_add_u32 s82, s81, 258048
    buffer_load_dwordx4 v54, s[44:47], s82 offen lds
    s_add_u32 m0, s80, 35840
    s_add_u32 s82, s81, 272384
    buffer_load_dwordx4 v54, s[44:47], s82 offen lds
    s_waitcnt vmcnt(20)
    s_add_u32 m0, s80, 36864
    s_add_u32 s82, s81, 286720
    buffer_load_dwordx4 v54, s[44:47], s82 offen lds
    s_add_u32 m0, s80, 37888
    s_add_u32 s82, s81, 301056
    buffer_load_dwordx4 v54, s[44:47], s82 offen lds
    s_add_u32 m0, s80, 38912
    s_add_u32 s82, s81, 315392
    buffer_load_dwordx4 v54, s[44:47], s82 offen lds
    s_add_u32 m0, s80, 39936
    s_add_u32 s82, s81, 329728
    buffer_load_dwordx4 v54, s[44:47], s82 offen lds
    s_add_u32 m0, s80, 49152
    s_add_u32 s82, s81, 344064
    buffer_load_dwordx4 v54, s[44:47], s82 offen lds
    s_add_u32 m0, s80, 50176
    s_add_u32 s82, s81, 358400
    buffer_load_dwordx4 v54, s[44:47], s82 offen lds
    s_add_u32 m0, s80, 51200
    s_add_u32 s82, s81, 372736
    buffer_load_dwordx4 v54, s[44:47], s82 offen lds
    s_add_u32 m0, s80, 52224
    s_add_u32 s82, s81, 387072
    buffer_load_dwordx4 v54, s[44:47], s82 offen lds
    s_add_u32 m0, s80, 53248
    s_add_u32 s82, s81, 401408
    buffer_load_dwordx4 v54, s[44:47], s82 offen lds
    s_add_u32 m0, s80, 54272
    s_add_u32 s82, s81, 415744
    buffer_load_dwordx4 v54, s[44:47], s82 offen lds
    s_add_u32 m0, s80, 55296
    s_add_u32 s82, s81, 430080
    buffer_load_dwordx4 v54, s[44:47], s82 offen lds
    s_add_u32 m0, s80, 56320
    s_add_u32 s82, s81, 444416
    buffer_load_dwordx4 v54, s[44:47], s82 offen lds
    s_add_u32 m0, s80, 65536
    s_add_u32 s82, s81, 458752
    buffer_load_dwordx4 v54, s[44:47], s82 offen lds
    s_add_u32 m0, s80, 66560
    s_add_u32 s82, s81, 473088
    buffer_load_dwordx4 v54, s[44:47], s82 offen lds
    s_add_u32 m0, s80, 67584
    s_add_u32 s82, s81, 487424
    buffer_load_dwordx4 v54, s[44:47], s82 offen lds
    s_add_u32 m0, s80, 68608
    s_add_u32 s82, s81, 501760
    buffer_load_dwordx4 v54, s[44:47], s82 offen lds
    s_barrier
    s_lshl_b32 s55, s2, 1
    s_add_u32 s55, s55, s51
    s_mul_i32 s55, s55, 3584
    s_barrier
    s_add_u32 m0, s80, 69632
    s_add_u32 s82, s81, 516096
    buffer_load_dwordx4 v54, s[44:47], s82 offen lds
    s_add_u32 m0, s80, 70656
    s_add_u32 s82, s81, 530432
    buffer_load_dwordx4 v54, s[44:47], s82 offen lds
    s_add_u32 m0, s80, 71680
    s_add_u32 s82, s81, 544768
    buffer_load_dwordx4 v54, s[44:47], s82 offen lds
    s_add_u32 m0, s80, 72704
    s_add_u32 s82, s81, 559104
    buffer_load_dwordx4 v54, s[44:47], s82 offen lds
    s_add_u32 m0, s80, 81920
    s_add_u32 s82, s81, 573440
    buffer_load_dwordx4 v54, s[44:47], s82 offen lds
    s_add_u32 m0, s80, 82944
    s_add_u32 s82, s81, 587776
    buffer_load_dwordx4 v54, s[44:47], s82 offen lds
    s_add_u32 m0, s80, 83968
    s_add_u32 s82, s81, 602112
    buffer_load_dwordx4 v54, s[44:47], s82 offen lds
    s_add_u32 m0, s80, 84992
    s_add_u32 s82, s81, 616448
    buffer_load_dwordx4 v54, s[44:47], s82 offen lds
    s_barrier
    buffer_load_dword v61, v60, s[32:35], s55 offen
    s_add_u32 m0, s80, 86016
    s_add_u32 s82, s81, 630784
    buffer_load_dwordx4 v54, s[44:47], s82 offen lds
    s_add_u32 m0, s80, 87040
    s_add_u32 s82, s81, 645120
    buffer_load_dwordx4 v54, s[44:47], s82 offen lds
    s_add_u32 m0, s80, 88064
    s_add_u32 s82, s81, 659456
    buffer_load_dwordx4 v54, s[44:47], s82 offen lds
    s_add_u32 m0, s80, 89088
    s_add_u32 s82, s81, 673792
    buffer_load_dwordx4 v54, s[44:47], s82 offen lds
    s_add_u32 m0, s80, 98304
    s_add_u32 s82, s81, 688128
    buffer_load_dwordx4 v54, s[44:47], s82 offen lds
    s_add_u32 m0, s80, 99328
    s_add_u32 s82, s81, 702464
    buffer_load_dwordx4 v54, s[44:47], s82 offen lds
    s_add_u32 m0, s80, 100352
    s_add_u32 s82, s81, 716800
    buffer_load_dwordx4 v54, s[44:47], s82 offen lds
    s_add_u32 m0, s80, 101376
    s_add_u32 s82, s81, 731136
    buffer_load_dwordx4 v54, s[44:47], s82 offen lds
    s_add_u32 m0, s80, 102400
    s_add_u32 s82, s81, 745472
    buffer_load_dwordx4 v54, s[44:47], s82 offen lds
    s_add_u32 m0, s80, 103424
    s_add_u32 s82, s81, 759808
    buffer_load_dwordx4 v54, s[44:47], s82 offen lds
    s_add_u32 m0, s80, 104448
    s_add_u32 s82, s81, 774144
    buffer_load_dwordx4 v54, s[44:47], s82 offen lds
    s_add_u32 m0, s80, 105472
    s_add_u32 s82, s81, 788480
    buffer_load_dwordx4 v54, s[44:47], s82 offen lds
    s_add_u32 m0, s80, 114688
    s_add_u32 s82, s81, 802816
    buffer_load_dwordx4 v54, s[44:47], s82 offen lds
    s_add_u32 m0, s80, 115712
    s_add_u32 s82, s81, 817152
    buffer_load_dwordx4 v54, s[44:47], s82 offen lds
    s_add_u32 m0, s80, 116736
    s_add_u32 s82, s81, 831488
    buffer_load_dwordx4 v54, s[44:47], s82 offen lds
    s_add_u32 m0, s80, 117760
    s_add_u32 s82, s81, 845824
    buffer_load_dwordx4 v54, s[44:47], s82 offen lds
    s_add_u32 m0, s80, 118784
    s_add_u32 s82, s81, 860160
    buffer_load_dwordx4 v54, s[44:47], s82 offen lds
    s_add_u32 m0, s80, 119808
    s_add_u32 s82, s81, 874496
    buffer_load_dwordx4 v54, s[44:47], s82 offen lds
    s_add_u32 m0, s80, 120832
    s_add_u32 s82, s81, 888832
    buffer_load_dwordx4 v54, s[44:47], s82 offen lds
    s_add_u32 m0, s80, 121856
    s_add_u32 s82, s81, 903168
    buffer_load_dwordx4 v54, s[44:47], s82 offen lds
    v_bfe_u32 v48, v0, 4, 1
    v_lshrrev_b32 v49, 5, v0
    v_bfe_u32 v50, v0, 2, 2
    v_and_b32 v51, 3, v0
    v_lshl_add_u32 v52, v50, 1, v48
    v_xor_b32 v52, s48, v52
    v_lshlrev_b32 v52, 5, v52
    v_lshl_add_u32 v52, v51, 3, v52
    v_lshl_add_u32 v49, v49, 3, v50
    v_lshl_add_u32 v52, v49, 8, v52
    v_lshl_add_u32 v52, v48, 13, v52
    v_add_u32 v53, 0x10000, v52
    v_lshrrev_b32 v16, 3, v0
    v_bfe_u32 v17, v0, 4, 1
    v_lshlrev_b32 v17, 2, v17
    v_and_b32 v18, 7, v0
    v_xor_b32 v17, v17, v18
    v_lshlrev_b32 v17, 4, v17
    v_lshl_add_u32 v10, v16, 7, v17
    s_movk_i32 s56, 896
    v_mad_u32_u24 v8, v16, s56, v17
    s_lshl_b32 s50, s48, 10
    s_mul_i32 s51, s90, 57344
    s_add_u32 s51, s51, s50
    s_add_u32 s51, s51, 4194304
    v_bfe_u32 v24, v0, 4, 1
    v_lshrrev_b32 v25, 5, v0
    v_bfe_u32 v26, v0, 2, 2
    v_and_b32 v27, 3, v0
    v_lshl_add_u32 v28, v26, 1, v24
    v_xor_b32 v28, s48, v28
    v_lshlrev_b32 v28, 5, v28
    v_lshl_add_u32 v28, v27, 3, v28
    v_lshl_add_u32 v25, v25, 3, v26
    v_lshl_add_u32 v28, v25, 8, v28
    v_lshl_add_u32 v28, v24, 13, v28
    v_add_u32 v28, 57344, v28
    v_add_u32 v29, 0x10000, v28
    v_mov_b32 v40, 0
    v_mov_b32 v41, 0
    v_mov_b32 v42, 0
    v_mov_b32 v43, 0
    v_mov_b32 v47, 0
    s_lshl_b32 s78, s91, 3
    s_add_u32 s78, s78, s48
    s_lshl_b32 s78, s78, 9
    s_add_u32 s78, s78, 2031616
    v_bfe_u32 v16, v0, 4, 1
    v_lshrrev_b32 v17, 5, v0
    v_bfe_u32 v18, v0, 2, 2
    v_and_b32 v19, 3, v0
    v_lshrrev_b32 v20, 1, v18
    v_lshlrev_b32 v21, 6, v20
    v_lshl_add_u32 v21, v16, 5, v21
    v_lshl_add_u32 v21, v19, 3, v21
    v_lshl_add_u32 v21, v18, 7, v21
    v_lshl_add_u32 v2, v17, 10, v21
    v_xor_b32 v3, 64, v2
    v_add_u32 v4, 57344, v2
    v_add_u32 v5, 57344, v3
    s_mul_i32 s53, s48, 6144
    s_add_u32 s52, s53, 114688
    s_mov_b32 s59, 114688
    v_lshl_add_u32 v21, v17, 9, v21
    v_add_u32 v6, s52, v21
    v_xor_b32 v7, 64, v6
    s_mul_i32 s54, s48, 200704
    s_lshl_b32 s56, s93, 7
    s_add_u32 s54, s54, s56
    v_lshlrev_b32 v9, 4, v0
    s_mul_i32 s55, s90, 448
    s_lshl_b32 s56, s91, 3
    s_add_u32 s55, s55, s56
    s_add_u32 s55, s55, s48
    s_lshl_b32 s55, s55, 10
    s_add_u32 s55, s55, 6291456
    v_and_b32 v11, 31, v0
    v_lshlrev_b32 v11, 3, v11
    s_lshl_b32 s58, s90, 9
    s_add_u32 s58, s58, 1851392
    s_lshl_b32 s60, s90, 12
    s_lshl4_add_u32 s60, s91, s60
    s_add_u32 s60, s60, 6160384
    v_lshrrev_b32 v36, 4, v0
    v_and_b32 v37, 3, v0
    v_lshl_add_u32 v36, v36, 2, v37
    v_bfe_u32 v37, v0, 2, 2
    v_lshl_add_u32 v36, v36, 2, v37
    v_lshlrev_b32 v36, 7, v36
    v_lshrrev_b32 v37, 1, v37
    v_xor_b32 v37, s92, v37
    v_lshl_add_u32 v36, v37, 6, v36
    s_lshl_b32 s56, s93, 13
    s_lshl_b32 s57, s48, 3
    s_add_u32 s56, s56, s57
    v_add_u32 v36, s56, v36
    v_add_u32 v38, 57344, v36
    s_lshl_b32 s56, s48, 13
    s_add_u32 s56, s56, 49152
    v_lshl_add_u32 v13, v0, 4, s56
    v_xor_b32 v14, 64, v13
    v_xor_b32 v15, 128, v13
    v_xor_b32 v16, 192, v13
    v_lshrrev_b32 v18, 3, v0
    v_bfe_u32 v20, v0, 2, 1
    v_and_b32 v21, 3, v0
    s_lshl_b32 s56, s48, 2
    v_add_u32 v30, s56, v21
    v_lshl_add_u32 v17, v20, 5, v30
    v_and_b32 v21, 3, v18
    v_lshlrev_b32 v21, 2, v21
    v_xor_b32 v17, v17, v21
    v_lshlrev_b32 v17, 4, v17
    v_lshl_add_u32 v17, v18, 10, v17
    v_lshrrev_b32 v19, 2, v0
    v_lshlrev_b32 v19, 3, v19
    s_movk_i32 s56, 896
    v_mad_u32_u24 v19, v30, s56, v19
    v_add_u32 v18, 49152, v17
    v_min_u32 v20, 13, v0
    v_lshlrev_b32 v20, 4, v20
    s_lshl4_add_u32 s74, s90, s91
    s_lshl_b32 s74, s74, 8
    s_add_u32 s74, s74, 6160384
    s_lshl2_add_u32 s73, s90, s92
    s_mul_i32 s73, s73, 112
    s_mul_i32 s56, s48, 14
    s_add_u32 s73, s73, s56
    s_lshl_b32 s73, s73, 10
    s_add_u32 s73, s73, 6291456
    s_lshl_b32 s76, s90, 1
    s_add_u32 s76, s76, s92
    s_mul_i32 s61, s76, 28672
    s_lshl_b32 s56, s93, 7
    s_add_u32 s61, s61, s56
    s_lshl_b32 s76, s76, 8
    s_lshl_b32 s56, s48, 5
    s_add_u32 s76, s76, s56
    s_add_u32 s76, s76, 1851392
    s_add_u32 s77, s76, 8192
    s_and_b32 s75, s2, 7
    s_lshl_b32 s75, s75, 9
    s_add_u32 s75, s75, 1982464
    s_add_u32 s72, s75, 256
    v_and_b32 v22, 1, v0
    v_lshlrev_b32 v22, 7, v22
    s_waitcnt vmcnt(0)
    s_barrier
    ds_read_b64_tr_b16 v[144:145], v52 offset:0
    ds_read_b64_tr_b16 v[146:147], v52 offset:1024
    ds_read_b64_tr_b16 v[148:149], v52 offset:4096
    ds_read_b64_tr_b16 v[150:151], v52 offset:5120
    ds_read_b64_tr_b16 v[152:153], v52 offset:16384
    ds_read_b64_tr_b16 v[154:155], v52 offset:17408
    ds_read_b64_tr_b16 v[156:157], v52 offset:20480
    ds_read_b64_tr_b16 v[158:159], v52 offset:21504
    ds_read_b64_tr_b16 v[160:161], v52 offset:32768
    ds_read_b64_tr_b16 v[162:163], v52 offset:33792
    ds_read_b64_tr_b16 v[164:165], v52 offset:36864
    ds_read_b64_tr_b16 v[166:167], v52 offset:37888
    ds_read_b64_tr_b16 v[168:169], v52 offset:49152
    ds_read_b64_tr_b16 v[170:171], v52 offset:50176
    ds_read_b64_tr_b16 v[172:173], v52 offset:53248
    ds_read_b64_tr_b16 v[174:175], v52 offset:54272
    ds_read_b64_tr_b16 v[176:177], v53 offset:0
    ds_read_b64_tr_b16 v[178:179], v53 offset:1024
    ds_read_b64_tr_b16 v[180:181], v53 offset:4096
    ds_read_b64_tr_b16 v[182:183], v53 offset:5120
    ds_read_b64_tr_b16 v[184:185], v53 offset:16384
    ds_read_b64_tr_b16 v[186:187], v53 offset:17408
    ds_read_b64_tr_b16 v[188:189], v53 offset:20480
    ds_read_b64_tr_b16 v[190:191], v53 offset:21504
    ds_read_b64_tr_b16 v[192:193], v53 offset:32768
    ds_read_b64_tr_b16 v[194:195], v53 offset:33792
    ds_read_b64_tr_b16 v[196:197], v53 offset:36864
    ds_read_b64_tr_b16 v[198:199], v53 offset:37888
    ds_read_b64_tr_b16 v[200:201], v53 offset:49152
    ds_read_b64_tr_b16 v[202:203], v53 offset:50176
    ds_read_b64_tr_b16 v[204:205], v53 offset:53248
    ds_read_b64_tr_b16 v[206:207], v53 offset:54272
    v_lshrrev_b32 v55, 4, v0
    v_and_b32 v56, 15, v0
    v_lshlrev_b32 v57, 2, v55
    v_xor_b32 v56, v56, v57
    s_and_b32 s80, s48, 1
    s_lshl_b32 s81, s80, 1
    v_xor_b32 v56, s81, v56
    s_movk_i32 s81, 3584
    v_lshlrev_b32 v57, 4, v56
    v_mad_u32_u24 v54, v55, s81, v57
    s_lshl_b32 s80, s80, 13
    s_lshl_b32 s81, s91, 8
    s_add_u32 s81, s81, 917504
    s_waitcnt lgkmcnt(0)
    s_barrier
    s_add_u32 m0, s80, 57344
    s_add_u32 s82, s81, 0
    buffer_load_dwordx4 v54, s[44:47], s82 offen lds
    s_add_u32 m0, s80, 58368
    s_add_u32 s82, s81, 14336
    buffer_load_dwordx4 v54, s[44:47], s82 offen lds
    s_add_u32 m0, s80, 59392
    s_add_u32 s82, s81, 28672
    buffer_load_dwordx4 v54, s[44:47], s82 offen lds
    s_add_u32 m0, s80, 60416
    s_add_u32 s82, s81, 43008
    buffer_load_dwordx4 v54, s[44:47], s82 offen lds
    s_add_u32 m0, s80, 61440
    s_add_u32 s82, s81, 57344
    buffer_load_dwordx4 v54, s[44:47], s82 offen lds
    s_add_u32 m0, s80, 62464
    s_add_u32 s82, s81, 71680
    buffer_load_dwordx4 v54, s[44:47], s82 offen lds
    s_add_u32 m0, s80, 63488
    s_add_u32 s82, s81, 86016
    buffer_load_dwordx4 v54, s[44:47], s82 offen lds
    s_add_u32 m0, s80, 64512
    s_add_u32 s82, s81, 100352
    buffer_load_dwordx4 v54, s[44:47], s82 offen lds
    s_add_u32 m0, s80, 73728
    s_add_u32 s82, s81, 114688
    buffer_load_dwordx4 v54, s[44:47], s82 offen lds
    s_add_u32 m0, s80, 74752
    s_add_u32 s82, s81, 129024
    buffer_load_dwordx4 v54, s[44:47], s82 offen lds
    s_add_u32 m0, s80, 75776
    s_add_u32 s82, s81, 143360
    buffer_load_dwordx4 v54, s[44:47], s82 offen lds
    s_add_u32 m0, s80, 76800
    s_add_u32 s82, s81, 157696
    buffer_load_dwordx4 v54, s[44:47], s82 offen lds
    s_add_u32 m0, s80, 77824
    s_add_u32 s82, s81, 172032
    buffer_load_dwordx4 v54, s[44:47], s82 offen lds
    s_add_u32 m0, s80, 78848
    s_add_u32 s82, s81, 186368
    buffer_load_dwordx4 v54, s[44:47], s82 offen lds
    s_add_u32 m0, s80, 79872
    s_add_u32 s82, s81, 200704
    buffer_load_dwordx4 v54, s[44:47], s82 offen lds
    s_add_u32 m0, s80, 80896
    s_add_u32 s82, s81, 215040
    buffer_load_dwordx4 v54, s[44:47], s82 offen lds
    s_add_u32 m0, s80, 90112
    s_add_u32 s82, s81, 229376
    buffer_load_dwordx4 v54, s[44:47], s82 offen lds
    s_add_u32 m0, s80, 91136
    s_add_u32 s82, s81, 243712
    buffer_load_dwordx4 v54, s[44:47], s82 offen lds
    s_add_u32 m0, s80, 92160
    s_add_u32 s82, s81, 258048
    buffer_load_dwordx4 v54, s[44:47], s82 offen lds
    s_add_u32 m0, s80, 93184
    s_add_u32 s82, s81, 272384
    buffer_load_dwordx4 v54, s[44:47], s82 offen lds
    s_add_u32 m0, s80, 94208
    s_add_u32 s82, s81, 286720
    buffer_load_dwordx4 v54, s[44:47], s82 offen lds
    s_add_u32 m0, s80, 95232
    s_add_u32 s82, s81, 301056
    buffer_load_dwordx4 v54, s[44:47], s82 offen lds
    s_add_u32 m0, s80, 96256
    s_add_u32 s82, s81, 315392
    buffer_load_dwordx4 v54, s[44:47], s82 offen lds
    s_add_u32 m0, s80, 97280
    s_add_u32 s82, s81, 329728
    buffer_load_dwordx4 v54, s[44:47], s82 offen lds
    s_add_u32 m0, s80, 106496
    s_add_u32 s82, s81, 344064
    buffer_load_dwordx4 v54, s[44:47], s82 offen lds
    s_add_u32 m0, s80, 107520
    s_add_u32 s82, s81, 358400
    buffer_load_dwordx4 v54, s[44:47], s82 offen lds
    s_add_u32 m0, s80, 108544
    s_add_u32 s82, s81, 372736
    buffer_load_dwordx4 v54, s[44:47], s82 offen lds
    s_add_u32 m0, s80, 109568
    s_add_u32 s82, s81, 387072
    buffer_load_dwordx4 v54, s[44:47], s82 offen lds
    s_add_u32 m0, s80, 110592
    s_add_u32 s82, s81, 401408
    buffer_load_dwordx4 v54, s[44:47], s82 offen lds
    s_add_u32 m0, s80, 111616
    s_add_u32 s82, s81, 415744
    buffer_load_dwordx4 v54, s[44:47], s82 offen lds
    s_add_u32 m0, s80, 112640
    s_add_u32 s82, s81, 430080
    buffer_load_dwordx4 v54, s[44:47], s82 offen lds
    s_add_u32 m0, s80, 113664
    s_add_u32 s82, s81, 444416
    buffer_load_dwordx4 v54, s[44:47], s82 offen lds
    s_add_u32 m0, s80, 122880
    s_add_u32 s82, s81, 458752
    buffer_load_dwordx4 v54, s[44:47], s82 offen lds
    s_add_u32 m0, s80, 123904
    s_add_u32 s82, s81, 473088
    buffer_load_dwordx4 v54, s[44:47], s82 offen lds
    s_add_u32 m0, s80, 124928
    s_add_u32 s82, s81, 487424
    buffer_load_dwordx4 v54, s[44:47], s82 offen lds
    s_add_u32 m0, s80, 125952
    s_add_u32 s82, s81, 501760
    buffer_load_dwordx4 v54, s[44:47], s82 offen lds
    s_add_u32 m0, s80, 126976
    s_add_u32 s82, s81, 516096
    buffer_load_dwordx4 v54, s[44:47], s82 offen lds
    s_add_u32 m0, s80, 128000
    s_add_u32 s82, s81, 530432
    buffer_load_dwordx4 v54, s[44:47], s82 offen lds
    s_add_u32 m0, s80, 129024
    s_add_u32 s82, s81, 544768
    buffer_load_dwordx4 v54, s[44:47], s82 offen lds
    s_add_u32 m0, s80, 130048
    s_add_u32 s82, s81, 559104
    buffer_load_dwordx4 v54, s[44:47], s82 offen lds
    s_add_u32 m0, s80, 139264
    s_add_u32 s82, s81, 573440
    buffer_load_dwordx4 v54, s[44:47], s82 offen lds
    s_add_u32 m0, s80, 140288
    s_add_u32 s82, s81, 587776
    buffer_load_dwordx4 v54, s[44:47], s82 offen lds
    s_add_u32 m0, s80, 141312
    s_add_u32 s82, s81, 602112
    buffer_load_dwordx4 v54, s[44:47], s82 offen lds
    s_add_u32 m0, s80, 142336
    s_add_u32 s82, s81, 616448
    buffer_load_dwordx4 v54, s[44:47], s82 offen lds
    s_add_u32 m0, s80, 143360
    s_add_u32 s82, s81, 630784
    buffer_load_dwordx4 v54, s[44:47], s82 offen lds
    s_add_u32 m0, s80, 144384
    s_add_u32 s82, s81, 645120
    buffer_load_dwordx4 v54, s[44:47], s82 offen lds
    s_add_u32 m0, s80, 145408
    s_add_u32 s82, s81, 659456
    buffer_load_dwordx4 v54, s[44:47], s82 offen lds
    s_add_u32 m0, s80, 146432
    s_add_u32 s82, s81, 673792
    buffer_load_dwordx4 v54, s[44:47], s82 offen lds
    s_branch L_nosetup
fj_2:
    v_lshrrev_b32 v16, 3, v0
    v_bfe_u32 v17, v0, 4, 1
    v_lshlrev_b32 v17, 2, v17
    v_and_b32 v18, 7, v0
    v_xor_b32 v17, v17, v18
    v_lshlrev_b32 v17, 4, v17
    v_lshl_add_u32 v10, v16, 7, v17
    s_movk_i32 s56, 896
    v_mad_u32_u24 v8, v16, s56, v17
    s_lshl_b32 s50, s48, 10
    s_mul_i32 s51, s90, 57344
    s_add_u32 s51, s51, s50
    s_add_u32 s51, s51, 4194304
    v_bfe_u32 v24, v0, 4, 1
    v_lshrrev_b32 v25, 5, v0
    v_bfe_u32 v26, v0, 2, 2
    v_and_b32 v27, 3, v0
    v_lshl_add_u32 v28, v26, 1, v24
    v_xor_b32 v28, s48, v28
    v_lshlrev_b32 v28, 5, v28
    v_lshl_add_u32 v28, v27, 3, v28
    v_lshl_add_u32 v25, v25, 3, v26
    v_lshl_add_u32 v28, v25, 8, v28
    v_lshl_add_u32 v28, v24, 13, v28
    v_add_u32 v28, 57344, v28
    v_add_u32 v29, 0x10000, v28
    v_mov_b32 v40, 0
    v_mov_b32 v41, 0
    v_mov_b32 v42, 0
    v_mov_b32 v43, 0
    v_mov_b32 v47, 0
    s_lshl_b32 s78, s91, 3
    s_add_u32 s78, s78, s48
    s_lshl_b32 s78, s78, 9
    s_add_u32 s78, s78, 2031616
    v_bfe_u32 v16, v0, 4, 1
    v_lshrrev_b32 v17, 5, v0
    v_bfe_u32 v18, v0, 2, 2
    v_and_b32 v19, 3, v0
    v_lshrrev_b32 v20, 1, v18
    v_lshlrev_b32 v21, 6, v20
    v_lshl_add_u32 v21, v16, 5, v21
    v_lshl_add_u32 v21, v19, 3, v21
    v_lshl_add_u32 v21, v18, 7, v21
    v_lshl_add_u32 v2, v17, 10, v21
    v_xor_b32 v3, 64, v2
    v_add_u32 v4, 57344, v2
    v_add_u32 v5, 57344, v3
    s_mul_i32 s53, s48, 6144
    s_add_u32 s52, s53, 114688
    s_mov_b32 s59, 114688
    v_lshl_add_u32 v21, v17, 9, v21
    v_add_u32 v6, s52, v21
    v_xor_b32 v7, 64, v6
    s_mul_i32 s54, s48, 200704
    s_lshl_b32 s56, s93, 7
    s_add_u32 s54, s54, s56
    v_lshlrev_b32 v9, 4, v0
    s_mul_i32 s55, s90, 448
    s_lshl_b32 s56, s91, 3
    s_add_u32 s55, s55, s56
    s_add_u32 s55, s55, s48
    s_lshl_b32 s55, s55, 10
    s_add_u32 s55, s55, 6291456
    v_and_b32 v11, 31, v0
    v_lshlrev_b32 v11, 3, v11
    s_lshl_b32 s58, s90, 9
    s_add_u32 s58, s58, 1851392
    s_lshl_b32 s60, s90, 12
    s_lshl4_add_u32 s60, s91, s60
    s_add_u32 s60, s60, 6160384
    v_lshrrev_b32 v36, 4, v0
    v_and_b32 v37, 3, v0
    v_lshl_add_u32 v36, v36, 2, v37
    v_bfe_u32 v37, v0, 2, 2
    v_lshl_add_u32 v36, v36, 2, v37
    v_lshlrev_b32 v36, 7, v36
    v_lshrrev_b32 v37, 1, v37
    v_xor_b32 v37, s92, v37
    v_lshl_add_u32 v36, v37, 6, v36
    s_lshl_b32 s56, s93, 13
    s_lshl_b32 s57, s48, 3
    s_add_u32 s56, s56, s57
    v_add_u32 v36, s56, v36
    v_add_u32 v38, 57344, v36
    s_lshl_b32 s56, s48, 13
    s_add_u32 s56, s56, 49152
    v_lshl_add_u32 v13, v0, 4, s56
    v_xor_b32 v14, 64, v13
    v_xor_b32 v15, 128, v13
    v_xor_b32 v16, 192, v13
    v_lshrrev_b32 v18, 3, v0
    v_bfe_u32 v20, v0, 2, 1
    v_and_b32 v21, 3, v0
    s_lshl_b32 s56, s48, 2
    v_add_u32 v30, s56, v21
    v_lshl_add_u32 v17, v20, 5, v30
    v_and_b32 v21, 3, v18
    v_lshlrev_b32 v21, 2, v21
    v_xor_b32 v17, v17, v21
    v_lshlrev_b32 v17, 4, v17
    v_lshl_add_u32 v17, v18, 10, v17
    v_lshrrev_b32 v19, 2, v0
    v_lshlrev_b32 v19, 3, v19
    s_movk_i32 s56, 896
    v_mad_u32_u24 v19, v30, s56, v19
    v_add_u32 v18, 49152, v17
    v_min_u32 v20, 13, v0
    v_lshlrev_b32 v20, 4, v20
    s_lshl4_add_u32 s74, s90, s91
    s_lshl_b32 s74, s74, 8
    s_add_u32 s74, s74, 6160384
    s_lshl2_add_u32 s73, s90, s92
    s_mul_i32 s73, s73, 112
    s_mul_i32 s56, s48, 14
    s_add_u32 s73, s73, s56
    s_lshl_b32 s73, s73, 10
    s_add_u32 s73, s73, 6291456
    s_lshl_b32 s76, s90, 1
    s_add_u32 s76, s76, s92
    s_mul_i32 s61, s76, 28672
    s_lshl_b32 s56, s93, 7
    s_add_u32 s61, s61, s56
    s_lshl_b32 s76, s76, 8
    s_lshl_b32 s56, s48, 5
    s_add_u32 s76, s76, s56
    s_add_u32 s76, s76, 1851392
    s_add_u32 s77, s76, 8192
    s_and_b32 s75, s2, 7
    s_lshl_b32 s75, s75, 9
    s_add_u32 s75, s75, 1982464
    s_add_u32 s72, s75, 256
    v_and_b32 v22, 1, v0
    v_lshlrev_b32 v22, 7, v22
L_nosetup:
    s_waitcnt vmcnt(0)
    s_barrier
    s_cmp_lg_u32 s48, 0
    s_cbranch_scc1 nw0_15s
    buffer_load_dword v23, v22, s[40:43], s75 offen sc1
nw0_15s:
    ds_read_b64_tr_b16 v[208:209], v28 offset:0
    ds_read_b64_tr_b16 v[210:211], v28 offset:1024
    ds_read_b64_tr_b16 v[212:213], v28 offset:4096
    ds_read_b64_tr_b16 v[214:215], v28 offset:5120
    ds_read_b64_tr_b16 v[216:217], v28 offset:16384
    ds_read_b64_tr_b16 v[218:219], v28 offset:17408
    ds_read_b64_tr_b16 v[220:221], v28 offset:20480
    ds_read_b64_tr_b16 v[222:223], v28 offset:21504
    ds_read_b64_tr_b16 v[224:225], v28 offset:32768
    ds_read_b64_tr_b16 v[226:227], v28 offset:33792
    ds_read_b64_tr_b16 v[228:229], v28 offset:36864
    ds_read_b64_tr_b16 v[230:231], v28 offset:37888
    ds_read_b64_tr_b16 v[232:233], v28 offset:49152
    ds_read_b64_tr_b16 v[234:235], v28 offset:50176
    ds_read_b64_tr_b16 v[236:237], v28 offset:53248
    ds_read_b64_tr_b16 v[238:239], v28 offset:54272
    ds_read_b64_tr_b16 v[240:241], v29 offset:0
    ds_read_b64_tr_b16 v[242:243], v29 offset:1024
    ds_read_b64_tr_b16 v[244:245], v29 offset:4096
    ds_read_b64_tr_b16 v[246:247], v29 offset:5120
    ds_read_b64_tr_b16 v[248:249], v29 offset:16384
    ds_read_b64_tr_b16 v[250:251], v29 offset:17408
    ds_read_b64_tr_b16 v[252:253], v29 offset:20480
    ds_read_b64_tr_b16 v[254:255], v29 offset:21504
    s_cmp_lg_u32 s48, 0
    s_cbranch_scc1 nw0_15
    s_waitcnt vmcnt(0)
    s_mov_b32 s57, 0
gw_16:
    v_cmp_eq_u32 vcc, s3, v23
    s_cbranch_vccnz gw_17
    s_add_u32 s57, s57, 1
    s_cmp_gt_u32 s57, 0x40000
    s_cbranch_scc1 gw_17
    s_sleep 1
    s_and_b32 s56, s57, 3
    s_cmp_eq_u32 s56, 0
    s_cselect_b32 exec_lo, 3, 2
    s_mov_b32 exec_hi, 0
    buffer_load_dword v23, v22, s[40:43], s75 offen sc1
    s_mov_b64 exec, -1
    s_waitcnt vmcnt(0)
    s_branch gw_16
gw_17:
nw0_15:
    s_barrier
    s_add_u32 m0, s50, 0
    s_add_u32 s56, s51, 0
    buffer_load_dwordx4 v10, s[40:43], s56 offen sc1 lds
    s_add_u32 m0, s50, 8192
    s_add_u32 s56, s51, 8192
    buffer_load_dwordx4 v10, s[40:43], s56 offen sc1 lds
    s_add_u32 m0, s50, 16384
    s_add_u32 s56, s51, 16384
    buffer_load_dwordx4 v10, s[40:43], s56 offen sc1 lds
    s_add_u32 m0, s50, 24576
    s_add_u32 s56, s51, 24576
    buffer_load_dwordx4 v10, s[40:43], s56 offen sc1 lds
    s_waitcnt vmcnt(3)
    s_barrier
    ds_read_b64_tr_b16 v[56:57], v2 offset:0
    ds_read_b64_tr_b16 v[58:59], v2 offset:512
    ds_read_b64_tr_b16 v[60:61], v2 offset:2048
    ds_read_b64_tr_b16 v[62:63], v2 offset:2560
    ds_read_b64_tr_b16 v[64:65], v2 offset:4096
    ds_read_b64_tr_b16 v[66:67], v2 offset:4608
    s_waitcnt lgkmcnt(4)
    v_mfma_f32_32x32x16_bf16 v[80:95], v[144:147], v[56:59], 0
    ds_read_b64_tr_b16 v[68:69], v2 offset:6144
    ds_read_b64_tr_b16 v[70:71], v2 offset:6656
    s_add_u32 m0, s50, 32768
    s_add_u32 s56, s51, 32768
    buffer_load_dwordx4 v10, s[40:43], s56 offen sc1 lds
    s_waitcnt lgkmcnt(4)
    v_mfma_f32_32x32x16_bf16 v[80:95], v[148:151], v[60:63], v[80:95]
    s_waitcnt vmcnt(2)
    s_barrier
    ds_read_b64_tr_b16 v[72:73], v2 offset:8192
    ds_read_b64_tr_b16 v[74:75], v2 offset:8704
    s_add_u32 m0, s50, 40960
    s_add_u32 s56, s51, 40960
    buffer_load_dwordx4 v10, s[40:43], s56 offen sc1 lds
    s_waitcnt lgkmcnt(4)
    v_mfma_f32_32x32x16_bf16 v[80:95], v[152:155], v[64:67], v[80:95]
    ds_read_b64_tr_b16 v[76:77], v2 offset:10240
    ds_read_b64_tr_b16 v[78:79], v2 offset:10752
    s_add_u32 m0, s50, 49152
    s_add_u32 s56, s51, 49152
    buffer_load_dwordx4 v10, s[40:43], s56 offen sc1 lds
    s_waitcnt lgkmcnt(4)
    v_mfma_f32_32x32x16_bf16 v[80:95], v[156:159], v[68:71], v[80:95]
    ds_read_b64_tr_b16 v[56:57], v2 offset:12288
    ds_read_b64_tr_b16 v[58:59], v2 offset:12800
    s_waitcnt lgkmcnt(4)
    v_mfma_f32_32x32x16_bf16 v[80:95], v[160:163], v[72:75], v[80:95]
    ds_read_b64_tr_b16 v[60:61], v2 offset:14336
    ds_read_b64_tr_b16 v[62:63], v2 offset:14848
    s_waitcnt lgkmcnt(4)
    v_mfma_f32_32x32x16_bf16 v[80:95], v[164:167], v[76:79], v[80:95]
    ds_read_b64_tr_b16 v[64:65], v2 offset:16384
    ds_read_b64_tr_b16 v[66:67], v2 offset:16896
    s_waitcnt lgkmcnt(4)
    v_mfma_f32_32x32x16_bf16 v[80:95], v[168:171], v[56:59], v[80:95]
    ds_read_b64_tr_b16 v[68:69], v2 offset:18432
    ds_read_b64_tr_b16 v[70:71], v2 offset:18944
    s_waitcnt lgkmcnt(4)
    v_mfma_f32_32x32x16_bf16 v[80:95], v[172:175], v[60:63], v[80:95]
    ds_read_b64_tr_b16 v[72:73], v2 offset:20480
    ds_read_b64_tr_b16 v[74:75], v2 offset:20992
    s_waitcnt lgkmcnt(4)
    v_mfma_f32_32x32x16_bf16 v[80:95], v[176:179], v[64:67], v[80:95]
    ds_read_b64_tr_b16 v[76:77], v2 offset:22528
    ds_read_b64_tr_b16 v[78:79], v2 offset:23040
    s_mov_b32 exec_hi, 0
    buffer_load_dwordx4 v[40:43], v9, s[40:43], s78 offen sc1
    s_mov_b64 exec, -1
    s_waitcnt lgkmcnt(4)
    v_mfma_f32_32x32x16_bf16 v[80:95], v[180:183], v[68:71], v[80:95]
    s_waitcnt vmcnt(3)
    s_barrier
    ds_read_b64_tr_b16 v[56:57], v2 offset:24576
    ds_read_b64_tr_b16 v[58:59], v2 offset:25088
    s_waitcnt lgkmcnt(4)
    v_mfma_f32_32x32x16_bf16 v[80:95], v[184:187], v[72:75], v[80:95]
    ds_read_b64_tr_b16 v[60:61], v2 offset:26624
    ds_read_b64_tr_b16 v[62:63], v2 offset:27136
    s_add_u32 m0, s52, 0
    s_add_u32 s56, s54, 0
    buffer_load_dwordx4 v8, s[32:35], s56 offen  lds
    s_waitcnt lgkmcnt(4)
    v_mfma_f32_32x32x16_bf16 v[80:95], v[188:191], v[76:79], v[80:95]
    ds_read_b64_tr_b16 v[64:65], v2 offset:28672
    ds_read_b64_tr_b16 v[66:67], v2 offset:29184
    s_waitcnt lgkmcnt(4)
    v_mfma_f32_32x32x16_bf16 v[80:95], v[192:195], v[56:59], v[80:95]
    ds_read_b64_tr_b16 v[68:69], v2 offset:30720
    ds_read_b64_tr_b16 v[70:71], v2 offset:31232
    s_add_u32 m0, s52, 1024
    s_add_u32 s56, s54, 7168
    buffer_load_dwordx4 v8, s[32:35], s56 offen  lds
    s_waitcnt lgkmcnt(4)
    v_mfma_f32_32x32x16_bf16 v[80:95], v[196:199], v[60:63], v[80:95]
    ds_read_b64_tr_b16 v[72:73], v2 offset:32768
    ds_read_b64_tr_b16 v[74:75], v2 offset:33280
    s_waitcnt lgkmcnt(4)
    v_mfma_f32_32x32x16_bf16 v[80:95], v[200:203], v[64:67], v[80:95]
    ds_read_b64_tr_b16 v[76:77], v2 offset:34816
    ds_read_b64_tr_b16 v[78:79], v2 offset:35328
    s_add_u32 m0, s52, 2048
    s_add_u32 s56, s54, 14336
    buffer_load_dwordx4 v8, s[32:35], s56 offen  lds
    s_waitcnt lgkmcnt(4)
    v_mfma_f32_32x32x16_bf16 v[80:95], v[204:207], v[68:71], v[80:95]
    ds_read_b64_tr_b16 v[56:57], v2 offset:36864
    ds_read_b64_tr_b16 v[58:59], v2 offset:37376
    s_waitcnt lgkmcnt(4)
    v_mfma_f32_32x32x16_bf16 v[80:95], v[208:211], v[72:75], v[80:95]
    ds_read_b64_tr_b16 v[60:61], v2 offset:38912
    ds_read_b64_tr_b16 v[62:63], v2 offset:39424
    s_add_u32 m0, s52, 3072
    s_add_u32 s56, s54, 21504
    buffer_load_dwordx4 v8, s[32:35], s56 offen  lds
    s_waitcnt lgkmcnt(4)
    v_mfma_f32_32x32x16_bf16 v[80:95], v[212:215], v[76:79], v[80:95]
    s_waitcnt vmcnt(5)
    s_barrier
    ds_read_b64_tr_b16 v[64:65], v2 offset:40960
    ds_read_b64_tr_b16 v[66:67], v2 offset:41472
    s_waitcnt lgkmcnt(4)
    v_mfma_f32_32x32x16_bf16 v[80:95], v[216:219], v[56:59], v[80:95]
    ds_read_b64_tr_b16 v[68:69], v2 offset:43008
    ds_read_b64_tr_b16 v[70:71], v2 offset:43520
    s_add_u32 m0, s52, 4096
    s_add_u32 s56, s54, 28672
    buffer_load_dwordx4 v8, s[32:35], s56 offen  lds
    s_waitcnt lgkmcnt(4)
    v_mfma_f32_32x32x16_bf16 v[80:95], v[220:223], v[60:63], v[80:95]
    ds_read_b64_tr_b16 v[72:73], v2 offset:45056
    ds_read_b64_tr_b16 v[74:75], v2 offset:45568
    s_waitcnt lgkmcnt(4)
    v_mfma_f32_32x32x16_bf16 v[80:95], v[224:227], v[64:67], v[80:95]
    ds_read_b64_tr_b16 v[76:77], v2 offset:47104
    ds_read_b64_tr_b16 v[78:79], v2 offset:47616
    s_add_u32 m0, s52, 5120
    s_add_u32 s56, s54, 35840
    buffer_load_dwordx4 v8, s[32:35], s56 offen  lds
    s_waitcnt lgkmcnt(4)
    v_mfma_f32_32x32x16_bf16 v[80:95], v[228:231], v[68:71], v[80:95]
    ds_read_b64_tr_b16 v[56:57], v2 offset:49152
    ds_read_b64_tr_b16 v[58:59], v2 offset:49664
    s_waitcnt lgkmcnt(4)
    v_mfma_f32_32x32x16_bf16 v[80:95], v[232:235], v[72:75], v[80:95]
    ds_read_b64_tr_b16 v[60:61], v2 offset:51200
    ds_read_b64_tr_b16 v[62:63], v2 offset:51712
    ds_read_b64_tr_b16 v[64:65], v2 offset:53248
    ds_read_b64_tr_b16 v[66:67], v2 offset:53760
    s_waitcnt lgkmcnt(6)
    v_mfma_f32_32x32x16_bf16 v[80:95], v[236:239], v[76:79], v[80:95]
    ds_read_b64_tr_b16 v[68:69], v2 offset:55296
    ds_read_b64_tr_b16 v[70:71], v2 offset:55808
    ds_read_b64_tr_b16 v[72:73], v3 offset:0
    ds_read_b64_tr_b16 v[74:75], v3 offset:512
    buffer_load_dword v23, v22, s[40:43], s72 offen sc1
    s_waitcnt lgkmcnt(8)
    v_mfma_f32_32x32x16_bf16 v[80:95], v[240:243], v[56:59], v[80:95]
    ds_read_b64_tr_b16 v[76:77], v3 offset:2048
    ds_read_b64_tr_b16 v[78:79], v3 offset:2560
    s_waitcnt lgkmcnt(8)
    v_mfma_f32_32x32x16_bf16 v[80:95], v[244:247], v[60:63], v[80:95]
    ds_read_b64_tr_b16 v[56:57], v3 offset:4096
    ds_read_b64_tr_b16 v[58:59], v3 offset:4608
    s_waitcnt lgkmcnt(8)
    v_mfma_f32_32x32x16_bf16 v[80:95], v[248:251], v[64:67], v[80:95]
    ds_read_b64_tr_b16 v[60:61], v3 offset:6144
    ds_read_b64_tr_b16 v[62:63], v3 offset:6656
    ds_read_b64_tr_b16 v[36:37], v36
    buffer_load_dwordx2 v[32:33], v11, s[40:43], s58 offen offset:0 sc1
    buffer_load_dwordx2 v[34:35], v11, s[40:43], s58 offen offset:256 sc1
    s_waitcnt lgkmcnt(9)
    v_mfma_f32_32x32x16_bf16 v[80:95], v[252:255], v[68:71], v[80:95]
    ds_read_b64_tr_b16 v[64:65], v3 offset:8192
    ds_read_b64_tr_b16 v[66:67], v3 offset:8704
    s_barrier
    s_cmp_ge_u32 s48, 4
    s_cbranch_scc1 grpB_18
    s_setprio 1
    s_waitcnt lgkmcnt(7)
    v_mfma_f32_32x32x16_bf16 v[96:111], v[144:147], v[72:75], 0
    ds_read_b64_tr_b16 v[68:69], v3 offset:10240
    ds_read_b64_tr_b16 v[70:71], v3 offset:10752
    v_mfma_f32_32x32x16_bf16 v[96:111], v[148:151], v[76:79], v[96:111]
    ds_read_b64_tr_b16 v[72:73], v3 offset:12288
    ds_read_b64_tr_b16 v[74:75], v3 offset:12800
    s_waitcnt lgkmcnt(7)
    v_mfma_f32_32x32x16_bf16 v[96:111], v[152:155], v[56:59], v[96:111]
    ds_read_b64_tr_b16 v[76:77], v3 offset:14336
    ds_read_b64_tr_b16 v[78:79], v3 offset:14848
    v_mfma_f32_32x32x16_bf16 v[96:111], v[156:159], v[60:63], v[96:111]
    ds_read_b64_tr_b16 v[56:57], v3 offset:16384
    ds_read_b64_tr_b16 v[58:59], v3 offset:16896
    s_waitcnt lgkmcnt(6)
    v_mfma_f32_32x32x16_bf16 v[96:111], v[160:163], v[64:67], v[96:111]
    ds_read_b64_tr_b16 v[60:61], v3 offset:18432
    ds_read_b64_tr_b16 v[62:63], v3 offset:18944
    v_mfma_f32_32x32x16_bf16 v[96:111], v[164:167], v[68:71], v[96:111]
    ds_read_b64_tr_b16 v[64:65], v3 offset:20480
    ds_read_b64_tr_b16 v[66:67], v3 offset:20992
    s_waitcnt lgkmcnt(6)
    v_mfma_f32_32x32x16_bf16 v[96:111], v[168:171], v[72:75], v[96:111]
    ds_read_b64_tr_b16 v[68:69], v3 offset:22528
    ds_read_b64_tr_b16 v[70:71], v3 offset:23040
    v_mfma_f32_32x32x16_bf16 v[96:111], v[172:175], v[76:79], v[96:111]
    ds_read_b64_tr_b16 v[72:73], v3 offset:24576
    ds_read_b64_tr_b16 v[74:75], v3 offset:25088
    s_waitcnt lgkmcnt(6)
    v_mfma_f32_32x32x16_bf16 v[96:111], v[176:179], v[56:59], v[96:111]
    ds_read_b64_tr_b16 v[76:77], v3 offset:26624
    ds_read_b64_tr_b16 v[78:79], v3 offset:27136
    v_mfma_f32_32x32x16_bf16 v[96:111], v[180:183], v[60:63], v[96:111]
    ds_read_b64_tr_b16 v[56:57], v3 offset:28672
    ds_read_b64_tr_b16 v[58:59], v3 offset:29184
    s_waitcnt lgkmcnt(6)
    v_mfma_f32_32x32x16_bf16 v[96:111], v[184:187], v[64:67], v[96:111]
    ds_read_b64_tr_b16 v[60:61], v3 offset:30720
    ds_read_b64_tr_b16 v[62:63], v3 offset:31232
    s_waitcnt vmcnt(7)
    ds_read_b64_tr_b16 v[112:113], v6 offset:0
    v_mfma_f32_32x32x16_bf16 v[96:111], v[188:191], v[68:71], v[96:111]
    ds_read_b64_tr_b16 v[64:65], v3 offset:32768
    ds_read_b64_tr_b16 v[66:67], v3 offset:33280
    ds_read_b64_tr_b16 v[114:115], v6 offset:1024
    s_waitcnt lgkmcnt(8)
    v_mfma_f32_32x32x16_bf16 v[96:111], v[192:195], v[72:75], v[96:111]
    ds_read_b64_tr_b16 v[68:69], v3 offset:34816
    ds_read_b64_tr_b16 v[70:71], v3 offset:35328
    ds_read_b64_tr_b16 v[116:117], v7 offset:0
    v_mfma_f32_32x32x16_bf16 v[96:111], v[196:199], v[76:79], v[96:111]
    ds_read_b64_tr_b16 v[72:73], v3 offset:36864
    ds_read_b64_tr_b16 v[74:75], v3 offset:37376
    ds_read_b64_tr_b16 v[118:119], v7 offset:1024
    s_waitcnt lgkmcnt(10)
    v_mfma_f32_32x32x16_bf16 v[96:111], v[200:203], v[56:59], v[96:111]
    ds_read_b64_tr_b16 v[76:77], v3 offset:38912
    ds_read_b64_tr_b16 v[78:79], v3 offset:39424
    s_waitcnt vmcnt(5)
    ds_read_b64_tr_b16 v[120:121], v6 offset:2048
    v_mfma_f32_32x32x16_bf16 v[96:111], v[204:207], v[60:63], v[96:111]
    ds_read_b64_tr_b16 v[56:57], v3 offset:40960
    ds_read_b64_tr_b16 v[58:59], v3 offset:41472
    ds_read_b64_tr_b16 v[122:123], v6 offset:3072
    s_waitcnt lgkmcnt(10)
    v_mfma_f32_32x32x16_bf16 v[96:111], v[208:211], v[64:67], v[96:111]
    ds_read_b64_tr_b16 v[60:61], v3 offset:43008
    ds_read_b64_tr_b16 v[62:63], v3 offset:43520
    ds_read_b64_tr_b16 v[124:125], v7 offset:2048
    v_mfma_f32_32x32x16_bf16 v[96:111], v[212:215], v[68:71], v[96:111]
    ds_read_b64_tr_b16 v[64:65], v3 offset:45056
    ds_read_b64_tr_b16 v[66:67], v3 offset:45568
    ds_read_b64_tr_b16 v[126:127], v7 offset:3072
    s_waitcnt lgkmcnt(10)
    v_mfma_f32_32x32x16_bf16 v[96:111], v[216:219], v[72:75], v[96:111]
    ds_read_b64_tr_b16 v[68:69], v3 offset:47104
    ds_read_b64_tr_b16 v[70:71], v3 offset:47616
    s_waitcnt vmcnt(3)
    ds_read_b64_tr_b16 v[128:129], v6 offset:4096
    v_mfma_f32_32x32x16_bf16 v[96:111], v[220:223], v[76:79], v[96:111]
    ds_read_b64_tr_b16 v[72:73], v3 offset:49152
    ds_read_b64_tr_b16 v[74:75], v3 offset:49664
    ds_read_b64_tr_b16 v[130:131], v6 offset:5120
    s_waitcnt lgkmcnt(10)
    v_mfma_f32_32x32x16_bf16 v[96:111], v[224:227], v[56:59], v[96:111]
    ds_read_b64_tr_b16 v[76:77], v3 offset:51200
    ds_read_b64_tr_b16 v[78:79], v3 offset:51712
    ds_read_b64_tr_b16 v[132:133], v7 offset:4096
    v_mfma_f32_32x32x16_bf16 v[96:111], v[228:231], v[60:63], v[96:111]
    ds_read_b64_tr_b16 v[56:57], v3 offset:53248
    ds_read_b64_tr_b16 v[58:59], v3 offset:53760
    ds_read_b64_tr_b16 v[134:135], v7 offset:5120
    s_waitcnt lgkmcnt(10)
    v_mfma_f32_32x32x16_bf16 v[96:111], v[232:235], v[64:67], v[96:111]
    ds_read_b64_tr_b16 v[60:61], v3 offset:55296
    ds_read_b64_tr_b16 v[62:63], v3 offset:55808
    v_mfma_f32_32x32x16_bf16 v[96:111], v[236:239], v[68:71], v[96:111]
    s_waitcnt lgkmcnt(6)
    v_mfma_f32_32x32x16_bf16 v[96:111], v[240:243], v[72:75], v[96:111]
    v_mfma_f32_32x32x16_bf16 v[96:111], v[244:247], v[76:79], v[96:111]
    s_waitcnt lgkmcnt(0)
    v_mfma_f32_32x32x16_bf16 v[96:111], v[248:251], v[56:59], v[96:111]
    v_mfma_f32_32x32x16_bf16 v[96:111], v[252:255], v[60:63], v[96:111]
    s_setprio 0
    s_barrier
    s_waitcnt vmcnt(0)
    v_cmp_ne_u32 vcc, s3, v33
    v_cmp_ne_u32 s[62:63], s3, v35
    s_or_b64 vcc, vcc, s[62:63]
    s_mov_b32 s57, 0
    s_cbranch_vccz gro_20
grp_19:
    buffer_load_dwordx2 v[32:33], v11, s[40:43], s58 offen offset:0 sc1
    buffer_load_dwordx2 v[34:35], v11, s[40:43], s58 offen offset:256 sc1
    s_add_u32 s57, s57, 1
    s_cmp_gt_u32 s57, 0x40000
    s_cbranch_scc1 gro_20
    s_waitcnt vmcnt(0)
    v_cmp_ne_u32 vcc, s3, v33
    v_cmp_ne_u32 s[62:63], s3, v35
    s_or_b64 vcc, vcc, s[62:63]
    s_cbranch_vccnz grp_19
gro_20:
    v_mov_b32 v44, v32
    v_mov_b32 v45, v32
    v_mov_b32 v46, v32
    v_and_b32 v12, 0xffff0000, v32
    v_rcp_f32 v12, v12
    s_setprio 3
    v_mfma_f32_32x32x16_bf16 v[80:95], v[40:43], v[44:47], v[80:95]
    s_setprio 0
    v_mul_f32 v12, 0xbeeff558, v12
    s_add_u32 m0, s52, 0
    s_add_u32 s56, s54, 43008
    buffer_load_dwordx4 v8, s[32:35], s56 offen  lds
    s_add_u32 m0, s52, 1024
    s_add_u32 s56, s54, 50176
    buffer_load_dwordx4 v8, s[32:35], s56 offen  lds
    s_add_u32 m0, s52, 2048
    s_add_u32 s56, s54, 57344
    buffer_load_dwordx4 v8, s[32:35], s56 offen  lds
    s_add_u32 m0, s52, 3072
    s_add_u32 s56, s54, 64512
    buffer_load_dwordx4 v8, s[32:35], s56 offen  lds
    v_mul_f32 v80, v80, v12
    v_mul_f32 v81, v81, v12
    v_mul_f32 v82, v82, v12
    v_fmaak_f32 v24, v80, v80, 0x409d30fc
    v_mul_f32 v83, v83, v12
    v_fmaak_f32 v25, v81, v81, 0x409d30fc
    v_mul_f32 v84, v84, v12
    v_fmaak_f32 v26, v82, v82, 0x409d30fc
    v_mul_f32 v24, v24, v80
    v_mul_f32 v85, v85, v12
    v_fmaak_f32 v27, v83, v83, 0x409d30fc
    v_mul_f32 v25, v25, v81
    v_mul_f32 v86, v86, v12
    s_add_u32 m0, s52, 4096
    s_add_u32 s56, s54, 71680
    buffer_load_dwordx4 v8, s[32:35], s56 offen  lds
    v_fmaak_f32 v28, v84, v84, 0x409d30fc
    v_mul_f32 v26, v26, v82
    v_exp_f32 v24, v24
    v_mul_f32 v87, v87, v12
    v_fmaak_f32 v29, v85, v85, 0x409d30fc
    v_mul_f32 v27, v27, v83
    v_exp_f32 v25, v25
    v_fmaak_f32 v30, v86, v86, 0x409d30fc
    v_mul_f32 v28, v28, v84
    v_exp_f32 v26, v26
    v_mul_f32 v80, v80, v88
    v_fmaak_f32 v31, v87, v87, 0x409d30fc
    v_mul_f32 v29, v29, v85
    v_exp_f32 v27, v27
    s_add_u32 m0, s52, 5120
    s_add_u32 s56, s54, 78848
    buffer_load_dwordx4 v8, s[32:35], s56 offen  lds
    v_mul_f32 v81, v81, v89
    v_mul_f32 v30, v30, v86
    v_exp_f32 v28, v28
    v_mul_f32 v82, v82, v90
    v_add_f32 v24, 1.0, v24
    v_mul_f32 v31, v31, v87
    v_exp_f32 v29, v29
    v_mul_f32 v83, v83, v91
    v_add_f32 v25, 1.0, v25
    v_exp_f32 v30, v30
    v_mul_f32 v84, v84, v92
    v_add_f32 v26, 1.0, v26
    v_rcp_f32 v24, v24
    v_exp_f32 v31, v31
    v_mul_f32 v85, v85, v93
    v_add_f32 v27, 1.0, v27
    v_rcp_f32 v25, v25
    v_mul_f32 v86, v86, v94
    v_add_f32 v28, 1.0, v28
    v_rcp_f32 v26, v26
    v_mul_f32 v87, v87, v95
    v_add_f32 v29, 1.0, v29
    v_rcp_f32 v27, v27
    v_add_f32 v30, 1.0, v30
    v_rcp_f32 v28, v28
    v_mul_f32 v80, v80, v24
    v_add_f32 v31, 1.0, v31
    v_rcp_f32 v29, v29
    v_mul_f32 v81, v81, v25
    v_rcp_f32 v30, v30
    v_mul_f32 v82, v82, v26
    v_rcp_f32 v31, v31
    v_mul_f32 v83, v83, v27
    v_mul_f32 v84, v84, v28
    v_mul_f32 v85, v85, v29
    v_mul_f32 v86, v86, v30
    v_mul_f32 v87, v87, v31
    v_cvt_pk_bf16_f32 v88, v80, v81
    v_cvt_pk_bf16_f32 v89, v82, v83
    v_cvt_pk_bf16_f32 v90, v84, v85
    v_cvt_pk_bf16_f32 v91, v86, v87
    s_add_u32 s56, s55, 0
    buffer_store_dwordx4 v[88:91], v9, s[40:43], s56 offen sc1
    v_mov_b32 v44, v34
    v_mov_b32 v45, v34
    v_mov_b32 v46, v34
    s_barrier
    s_setprio 1
    ds_read_b64_tr_b16 v[64:65], v4 offset:0
    ds_read_b64_tr_b16 v[66:67], v4 offset:512
    ds_read_b64_tr_b16 v[68:69], v4 offset:2048
    ds_read_b64_tr_b16 v[70:71], v4 offset:2560
    ds_read_b64_tr_b16 v[72:73], v4 offset:4096
    ds_read_b64_tr_b16 v[74:75], v4 offset:4608
    ds_read_b64_tr_b16 v[76:77], v4 offset:6144
    ds_read_b64_tr_b16 v[78:79], v4 offset:6656
    ds_read_b64_tr_b16 v[56:57], v4 offset:8192
    ds_read_b64_tr_b16 v[58:59], v4 offset:8704
    s_nop 0
    v_mfma_f32_32x32x16_bf16 v[96:111], v[40:43], v[44:47], v[96:111]
    s_waitcnt lgkmcnt(6)
    v_mfma_f32_32x32x16_bf16 v[80:95], v[144:147], v[64:67], 0
    ds_read_b64_tr_b16 v[60:61], v4 offset:10240
    ds_read_b64_tr_b16 v[62:63], v4 offset:10752
    v_mfma_f32_32x32x16_bf16 v[80:95], v[148:151], v[68:71], v[80:95]
    ds_read_b64_tr_b16 v[64:65], v4 offset:12288
    ds_read_b64_tr_b16 v[66:67], v4 offset:12800
    s_waitcnt lgkmcnt(6)
    v_mfma_f32_32x32x16_bf16 v[80:95], v[152:155], v[72:75], v[80:95]
    ds_read_b64_tr_b16 v[68:69], v4 offset:14336
    ds_read_b64_tr_b16 v[70:71], v4 offset:14848
    v_mfma_f32_32x32x16_bf16 v[80:95], v[156:159], v[76:79], v[80:95]
    ds_read_b64_tr_b16 v[72:73], v4 offset:16384
    ds_read_b64_tr_b16 v[74:75], v4 offset:16896
    s_waitcnt lgkmcnt(6)
    v_mfma_f32_32x32x16_bf16 v[80:95], v[160:163], v[56:59], v[80:95]
    ds_read_b64_tr_b16 v[76:77], v4 offset:18432
    ds_read_b64_tr_b16 v[78:79], v4 offset:18944
    v_mfma_f32_32x32x16_bf16 v[80:95], v[164:167], v[60:63], v[80:95]
    ds_read_b64_tr_b16 v[56:57], v4 offset:20480
    ds_read_b64_tr_b16 v[58:59], v4 offset:20992
    s_waitcnt lgkmcnt(6)
    v_mfma_f32_32x32x16_bf16 v[80:95], v[168:171], v[64:67], v[80:95]
    ds_read_b64_tr_b16 v[60:61], v4 offset:22528
    ds_read_b64_tr_b16 v[62:63], v4 offset:23040
    v_mfma_f32_32x32x16_bf16 v[80:95], v[172:175], v[68:71], v[80:95]
    ds_read_b64_tr_b16 v[64:65], v4 offset:24576
    ds_read_b64_tr_b16 v[66:67], v4 offset:25088
    s_waitcnt lgkmcnt(6)
    v_mfma_f32_32x32x16_bf16 v[80:95], v[176:179], v[72:75], v[80:95]
    ds_read_b64_tr_b16 v[68:69], v4 offset:26624
    ds_read_b64_tr_b16 v[70:71], v4 offset:27136
    s_waitcnt vmcnt(5)
    ds_read_b64_tr_b16 v[136:137], v6 offset:0
    v_mfma_f32_32x32x16_bf16 v[80:95], v[180:183], v[76:79], v[80:95]
    ds_read_b64_tr_b16 v[72:73], v4 offset:28672
    ds_read_b64_tr_b16 v[74:75], v4 offset:29184
    s_waitcnt lgkmcnt(7)
    v_mfma_f32_32x32x16_bf16 v[80:95], v[184:187], v[56:59], v[80:95]
    ds_read_b64_tr_b16 v[76:77], v4 offset:30720
    ds_read_b64_tr_b16 v[78:79], v4 offset:31232
    ds_read_b64_tr_b16 v[138:139], v6 offset:1024
    v_mfma_f32_32x32x16_bf16 v[80:95], v[188:191], v[60:63], v[80:95]
    ds_read_b64_tr_b16 v[56:57], v4 offset:32768
    ds_read_b64_tr_b16 v[58:59], v4 offset:33280
    s_waitcnt lgkmcnt(8)
    v_mfma_f32_32x32x16_bf16 v[80:95], v[192:195], v[64:67], v[80:95]
    ds_read_b64_tr_b16 v[60:61], v4 offset:34816
    ds_read_b64_tr_b16 v[62:63], v4 offset:35328
    ds_read_b64_tr_b16 v[140:141], v7 offset:0
    v_mfma_f32_32x32x16_bf16 v[80:95], v[196:199], v[68:71], v[80:95]
    ds_read_b64_tr_b16 v[64:65], v4 offset:36864
    ds_read_b64_tr_b16 v[66:67], v4 offset:37376
    s_waitcnt lgkmcnt(8)
    v_mfma_f32_32x32x16_bf16 v[80:95], v[200:203], v[72:75], v[80:95]
    ds_read_b64_tr_b16 v[68:69], v4 offset:38912
    ds_read_b64_tr_b16 v[70:71], v4 offset:39424
    ds_read_b64_tr_b16 v[142:143], v7 offset:1024
    v_mfma_f32_32x32x16_bf16 v[80:95], v[204:207], v[76:79], v[80:95]
    ds_read_b64_tr_b16 v[72:73], v4 offset:40960
    ds_read_b64_tr_b16 v[74:75], v4 offset:41472
    s_waitcnt lgkmcnt(8)
    v_mfma_f32_32x32x16_bf16 v[80:95], v[208:211], v[56:59], v[80:95]
    ds_read_b64_tr_b16 v[76:77], v4 offset:43008
    ds_read_b64_tr_b16 v[78:79], v4 offset:43520
    s_waitcnt vmcnt(3)
    ds_read_b64_tr_b16 v[48:49], v6 offset:2048
    v_mfma_f32_32x32x16_bf16 v[80:95], v[212:215], v[60:63], v[80:95]
    ds_read_b64_tr_b16 v[56:57], v4 offset:45056
    ds_read_b64_tr_b16 v[58:59], v4 offset:45568
    s_waitcnt lgkmcnt(8)
    v_mfma_f32_32x32x16_bf16 v[80:95], v[216:219], v[64:67], v[80:95]
    ds_read_b64_tr_b16 v[60:61], v4 offset:47104
    ds_read_b64_tr_b16 v[62:63], v4 offset:47616
    ds_read_b64_tr_b16 v[50:51], v6 offset:3072
    v_mfma_f32_32x32x16_bf16 v[80:95], v[220:223], v[68:71], v[80:95]
    ds_read_b64_tr_b16 v[64:65], v4 offset:49152
    ds_read_b64_tr_b16 v[66:67], v4 offset:49664
    s_waitcnt lgkmcnt(8)
    v_mfma_f32_32x32x16_bf16 v[80:95], v[224:227], v[72:75], v[80:95]
    ds_read_b64_tr_b16 v[68:69], v4 offset:51200
    ds_read_b64_tr_b16 v[70:71], v4 offset:51712
    ds_read_b64_tr_b16 v[52:53], v7 offset:2048
    v_mfma_f32_32x32x16_bf16 v[80:95], v[228:231], v[76:79], v[80:95]
    ds_read_b64_tr_b16 v[72:73], v4 offset:53248
    ds_read_b64_tr_b16 v[74:75], v4 offset:53760
    s_waitcnt lgkmcnt(8)
    v_mfma_f32_32x32x16_bf16 v[80:95], v[232:235], v[56:59], v[80:95]
    ds_read_b64_tr_b16 v[76:77], v4 offset:55296
    ds_read_b64_tr_b16 v[78:79], v4 offset:55808
    ds_read_b64_tr_b16 v[54:55], v7 offset:3072
    v_mfma_f32_32x32x16_bf16 v[80:95], v[236:239], v[60:63], v[80:95]
    ds_read_b64_tr_b16 v[56:57], v5 offset:0
    ds_read_b64_tr_b16 v[58:59], v5 offset:512
    s_waitcnt lgkmcnt(8)
    v_mfma_f32_32x32x16_bf16 v[80:95], v[240:243], v[64:67], v[80:95]
    ds_read_b64_tr_b16 v[60:61], v5 offset:2048
    ds_read_b64_tr_b16 v[62:63], v5 offset:2560
    ds_read_b64_tr_b16 v[38:39], v38
    v_mfma_f32_32x32x16_bf16 v[80:95], v[244:247], v[68:71], v[80:95]
    ds_read_b64_tr_b16 v[64:65], v5 offset:4096
    ds_read_b64_tr_b16 v[66:67], v5 offset:4608
    s_waitcnt lgkmcnt(8)
    v_mfma_f32_32x32x16_bf16 v[80:95], v[248:251], v[72:75], v[80:95]
    ds_read_b64_tr_b16 v[68:69], v5 offset:6144
    ds_read_b64_tr_b16 v[70:71], v5 offset:6656
    v_mfma_f32_32x32x16_bf16 v[80:95], v[252:255], v[76:79], v[80:95]
    ds_read_b64_tr_b16 v[72:73], v5 offset:8192
    ds_read_b64_tr_b16 v[74:75], v5 offset:8704
    s_setprio 0
    s_barrier
    v_and_b32 v12, 0xffff0000, v34
    v_rcp_f32 v12, v12
    s_nop 0
    v_mul_f32 v12, 0xbeeff558, v12
    v_mul_f32 v96, v96, v12
    v_mul_f32 v97, v97, v12
    v_mul_f32 v98, v98, v12
    v_fmaak_f32 v24, v96, v96, 0x409d30fc
    v_mul_f32 v99, v99, v12
    s_add_u32 s58, s58, 8192
    buffer_load_dwordx2 v[32:33], v11, s[40:43], s58 offen offset:0 sc1
    buffer_load_dwordx2 v[34:35], v11, s[40:43], s58 offen offset:256 sc1
    v_fmaak_f32 v25, v97, v97, 0x409d30fc
    v_mul_f32 v100, v100, v12
    v_fmaak_f32 v26, v98, v98, 0x409d30fc
    v_mul_f32 v24, v24, v96
    v_mul_f32 v101, v101, v12
    s_add_u32 m0, s52, 0
    s_add_u32 s56, s54, 86016
    buffer_load_dwordx4 v8, s[32:35], s56 offen  lds
    v_fmaak_f32 v27, v99, v99, 0x409d30fc
    v_mul_f32 v25, v25, v97
    v_mul_f32 v102, v102, v12
    v_fmaak_f32 v28, v100, v100, 0x409d30fc
    v_mul_f32 v26, v26, v98
    s_add_u32 m0, s52, 1024
    s_add_u32 s56, s54, 93184
    buffer_load_dwordx4 v8, s[32:35], s56 offen  lds
    v_exp_f32 v24, v24
    v_mul_f32 v103, v103, v12
    v_fmaak_f32 v29, v101, v101, 0x409d30fc
    v_mul_f32 v27, v27, v99
    v_exp_f32 v25, v25
    s_waitcnt lgkmcnt(11)
    s_add_u32 m0, s52, 2048
    s_add_u32 s56, s54, 100352
    buffer_load_dwordx4 v8, s[32:35], s56 offen  lds
    v_fmaak_f32 v30, v102, v102, 0x409d30fc
    v_mul_f32 v28, v28, v100
    v_exp_f32 v26, v26
    v_mul_f32 v96, v96, v104
    v_fmaak_f32 v31, v103, v103, 0x409d30fc
    s_add_u32 m0, s52, 3072
    s_add_u32 s56, s54, 107520
    buffer_load_dwordx4 v8, s[32:35], s56 offen  lds
    v_mul_f32 v29, v29, v101
    v_exp_f32 v27, v27
    v_mul_f32 v97, v97, v105
    v_mul_f32 v30, v30, v102
    v_exp_f32 v28, v28
    v_mul_f32 v98, v98, v106
    s_add_u32 m0, s53, 0
    s_add_u32 s56, s54, 114688
    buffer_load_dwordx4 v8, s[32:35], s56 offen  lds
    v_add_f32 v24, 1.0, v24
    v_mul_f32 v31, v31, v103
    v_exp_f32 v29, v29
    v_mul_f32 v99, v99, v107
    v_add_f32 v25, 1.0, v25
    s_add_u32 m0, s53, 1024
    s_add_u32 s56, s54, 121856
    buffer_load_dwordx4 v8, s[32:35], s56 offen  lds
    v_exp_f32 v30, v30
    v_mul_f32 v100, v100, v108
    v_add_f32 v26, 1.0, v26
    v_rcp_f32 v24, v24
    v_exp_f32 v31, v31
    s_add_u32 m0, s53, 2048
    s_add_u32 s56, s54, 129024
    buffer_load_dwordx4 v8, s[32:35], s56 offen  lds
    v_mul_f32 v101, v101, v109
    v_add_f32 v27, 1.0, v27
    v_rcp_f32 v25, v25
    v_mul_f32 v102, v102, v110
    v_add_f32 v28, 1.0, v28
    s_add_u32 m0, s53, 3072
    s_add_u32 s56, s54, 136192
    buffer_load_dwordx4 v8, s[32:35], s56 offen  lds
    v_rcp_f32 v26, v26
    v_mul_f32 v103, v103, v111
    v_add_f32 v29, 1.0, v29
    v_rcp_f32 v27, v27
    v_add_f32 v30, 1.0, v30
    s_add_u32 m0, s53, 4096
    s_add_u32 s56, s54, 143360
    buffer_load_dwordx4 v8, s[32:35], s56 offen  lds
    v_rcp_f32 v28, v28
    v_mul_f32 v96, v96, v24
    v_add_f32 v31, 1.0, v31
    v_rcp_f32 v29, v29
    v_mul_f32 v97, v97, v25
    s_add_u32 m0, s53, 5120
    s_add_u32 s56, s54, 150528
    buffer_load_dwordx4 v8, s[32:35], s56 offen  lds
    v_rcp_f32 v30, v30
    v_mul_f32 v98, v98, v26
    v_rcp_f32 v31, v31
    v_mul_f32 v99, v99, v27
    v_mul_f32 v100, v100, v28
    v_mul_f32 v101, v101, v29
    v_mul_f32 v102, v102, v30
    v_mul_f32 v103, v103, v31
    v_cvt_pk_bf16_f32 v104, v96, v97
    v_cvt_pk_bf16_f32 v105, v98, v99
    v_cvt_pk_bf16_f32 v106, v100, v101
    v_cvt_pk_bf16_f32 v107, v102, v103
    s_add_u32 s56, s55, 114688
    buffer_store_dwordx4 v[104:107], v9, s[40:43], s56 offen sc1
    s_waitcnt vmcnt(11)
    v_cmp_ne_u32 vcc, s3, v33
    v_cmp_ne_u32 s[62:63], s3, v35
    s_or_b64 vcc, vcc, s[62:63]
    s_mov_b32 s57, 0
    s_cbranch_vccz gro_22
grp_21:
    buffer_load_dwordx2 v[32:33], v11, s[40:43], s58 offen offset:0 sc1
    buffer_load_dwordx2 v[34:35], v11, s[40:43], s58 offen offset:256 sc1
    s_add_u32 s57, s57, 1
    s_cmp_gt_u32 s57, 0x40000
    s_cbranch_scc1 gro_22
    s_waitcnt vmcnt(0)
    v_cmp_ne_u32 vcc, s3, v33
    v_cmp_ne_u32 s[62:63], s3, v35
    s_or_b64 vcc, vcc, s[62:63]
    s_cbranch_vccnz grp_21
gro_22:
    v_mov_b32 v44, v32
    v_mov_b32 v45, v32
    v_mov_b32 v46, v32
    s_barrier
    s_setprio 1
    s_nop 0
    v_mfma_f32_32x32x16_bf16 v[80:95], v[40:43], v[44:47], v[80:95]
    s_waitcnt lgkmcnt(7)
    v_mfma_f32_32x32x16_bf16 v[96:111], v[144:147], v[56:59], 0
    ds_read_b64_tr_b16 v[76:77], v5 offset:10240
    ds_read_b64_tr_b16 v[78:79], v5 offset:10752
    v_mfma_f32_32x32x16_bf16 v[96:111], v[148:151], v[60:63], v[96:111]
    ds_read_b64_tr_b16 v[56:57], v5 offset:12288
    ds_read_b64_tr_b16 v[58:59], v5 offset:12800
    s_waitcnt lgkmcnt(6)
    v_mfma_f32_32x32x16_bf16 v[96:111], v[152:155], v[64:67], v[96:111]
    ds_read_b64_tr_b16 v[60:61], v5 offset:14336
    ds_read_b64_tr_b16 v[62:63], v5 offset:14848
    v_mfma_f32_32x32x16_bf16 v[96:111], v[156:159], v[68:71], v[96:111]
    ds_read_b64_tr_b16 v[64:65], v5 offset:16384
    ds_read_b64_tr_b16 v[66:67], v5 offset:16896
    ds_read_b64_tr_b16 v[144:145], v6 offset:4096
    s_waitcnt lgkmcnt(7)
    v_mfma_f32_32x32x16_bf16 v[96:111], v[160:163], v[72:75], v[96:111]
    ds_read_b64_tr_b16 v[68:69], v5 offset:18432
    ds_read_b64_tr_b16 v[70:71], v5 offset:18944
    ds_read_b64_tr_b16 v[146:147], v6 offset:5120
    v_mfma_f32_32x32x16_bf16 v[96:111], v[164:167], v[76:79], v[96:111]
    ds_read_b64_tr_b16 v[72:73], v5 offset:20480
    ds_read_b64_tr_b16 v[74:75], v5 offset:20992
    ds_read_b64_tr_b16 v[148:149], v7 offset:4096
    s_waitcnt lgkmcnt(9)
    v_mfma_f32_32x32x16_bf16 v[96:111], v[168:171], v[56:59], v[96:111]
    ds_read_b64_tr_b16 v[76:77], v5 offset:22528
    ds_read_b64_tr_b16 v[78:79], v5 offset:23040
    ds_read_b64_tr_b16 v[150:151], v7 offset:5120
    v_mfma_f32_32x32x16_bf16 v[96:111], v[172:175], v[60:63], v[96:111]
    ds_read_b64_tr_b16 v[56:57], v5 offset:24576
    ds_read_b64_tr_b16 v[58:59], v5 offset:25088
    s_waitcnt vmcnt(9)
    ds_read_b64_tr_b16 v[152:153], v6 offset:0
    s_waitcnt lgkmcnt(10)
    v_mfma_f32_32x32x16_bf16 v[96:111], v[176:179], v[64:67], v[96:111]
    ds_read_b64_tr_b16 v[60:61], v5 offset:26624
    ds_read_b64_tr_b16 v[62:63], v5 offset:27136
    ds_read_b64_tr_b16 v[154:155], v6 offset:1024
    v_mfma_f32_32x32x16_bf16 v[96:111], v[180:183], v[68:71], v[96:111]
    ds_read_b64_tr_b16 v[64:65], v5 offset:28672
    ds_read_b64_tr_b16 v[66:67], v5 offset:29184
    ds_read_b64_tr_b16 v[156:157], v7 offset:0
    s_waitcnt lgkmcnt(10)
    v_mfma_f32_32x32x16_bf16 v[96:111], v[184:187], v[72:75], v[96:111]
    ds_read_b64_tr_b16 v[68:69], v5 offset:30720
    ds_read_b64_tr_b16 v[70:71], v5 offset:31232
    ds_read_b64_tr_b16 v[158:159], v7 offset:1024
    v_mfma_f32_32x32x16_bf16 v[96:111], v[188:191], v[76:79], v[96:111]
    ds_read_b64_tr_b16 v[72:73], v5 offset:32768
    ds_read_b64_tr_b16 v[74:75], v5 offset:33280
    s_waitcnt vmcnt(7)
    ds_read_b64_tr_b16 v[160:161], v6 offset:2048
    s_waitcnt lgkmcnt(10)
    v_mfma_f32_32x32x16_bf16 v[96:111], v[192:195], v[56:59], v[96:111]
    ds_read_b64_tr_b16 v[76:77], v5 offset:34816
    ds_read_b64_tr_b16 v[78:79], v5 offset:35328
    ds_read_b64_tr_b16 v[162:163], v6 offset:3072
    v_mfma_f32_32x32x16_bf16 v[96:111], v[196:199], v[60:63], v[96:111]
    ds_read_b64_tr_b16 v[56:57], v5 offset:36864
    ds_read_b64_tr_b16 v[58:59], v5 offset:37376
    ds_read_b64_tr_b16 v[164:165], v7 offset:2048
    s_waitcnt lgkmcnt(10)
    v_mfma_f32_32x32x16_bf16 v[96:111], v[200:203], v[64:67], v[96:111]
    ds_read_b64_tr_b16 v[60:61], v5 offset:38912
    ds_read_b64_tr_b16 v[62:63], v5 offset:39424
    ds_read_b64_tr_b16 v[166:167], v7 offset:3072
    v_mfma_f32_32x32x16_bf16 v[96:111], v[204:207], v[68:71], v[96:111]
    ds_read_b64_tr_b16 v[64:65], v5 offset:40960
    ds_read_b64_tr_b16 v[66:67], v5 offset:41472
    v_subrev_u32 v6, s59, v6
    v_subrev_u32 v7, s59, v7
    s_waitcnt vmcnt(5)
    ds_read_b64_tr_b16 v[168:169], v6 offset:0
    s_waitcnt lgkmcnt(10)
    v_mfma_f32_32x32x16_bf16 v[96:111], v[208:211], v[72:75], v[96:111]
    ds_read_b64_tr_b16 v[68:69], v5 offset:43008
    ds_read_b64_tr_b16 v[70:71], v5 offset:43520
    ds_read_b64_tr_b16 v[170:171], v6 offset:1024
    v_mfma_f32_32x32x16_bf16 v[96:111], v[212:215], v[76:79], v[96:111]
    ds_read_b64_tr_b16 v[72:73], v5 offset:45056
    ds_read_b64_tr_b16 v[74:75], v5 offset:45568
    ds_read_b64_tr_b16 v[172:173], v7 offset:0
    s_waitcnt lgkmcnt(10)
    v_mfma_f32_32x32x16_bf16 v[96:111], v[216:219], v[56:59], v[96:111]
    ds_read_b64_tr_b16 v[76:77], v5 offset:47104
    ds_read_b64_tr_b16 v[78:79], v5 offset:47616
    ds_read_b64_tr_b16 v[174:175], v7 offset:1024
    v_mfma_f32_32x32x16_bf16 v[96:111], v[220:223], v[60:63], v[96:111]
    ds_read_b64_tr_b16 v[56:57], v5 offset:49152
    ds_read_b64_tr_b16 v[58:59], v5 offset:49664
    s_waitcnt vmcnt(3)
    ds_read_b64_tr_b16 v[176:177], v6 offset:2048
    s_waitcnt lgkmcnt(10)
    v_mfma_f32_32x32x16_bf16 v[96:111], v[224:227], v[64:67], v[96:111]
    ds_read_b64_tr_b16 v[60:61], v5 offset:51200
    ds_read_b64_tr_b16 v[62:63], v5 offset:51712
    ds_read_b64_tr_b16 v[178:179], v6 offset:3072
    v_mfma_f32_32x32x16_bf16 v[96:111], v[228:231], v[68:71], v[96:111]
    ds_read_b64_tr_b16 v[64:65], v5 offset:53248
    ds_read_b64_tr_b16 v[66:67], v5 offset:53760
    ds_read_b64_tr_b16 v[180:181], v7 offset:2048
    s_waitcnt lgkmcnt(10)
    v_mfma_f32_32x32x16_bf16 v[96:111], v[232:235], v[72:75], v[96:111]
    ds_read_b64_tr_b16 v[68:69], v5 offset:55296
    ds_read_b64_tr_b16 v[70:71], v5 offset:55808
    ds_read_b64_tr_b16 v[182:183], v7 offset:3072
    v_mfma_f32_32x32x16_bf16 v[96:111], v[236:239], v[76:79], v[96:111]
    s_waitcnt vmcnt(1)
    ds_read_b64_tr_b16 v[184:185], v6 offset:4096
    s_waitcnt lgkmcnt(8)
    v_mfma_f32_32x32x16_bf16 v[96:111], v[240:243], v[56:59], v[96:111]
    ds_read_b64_tr_b16 v[186:187], v6 offset:5120
    v_mfma_f32_32x32x16_bf16 v[96:111], v[244:247], v[60:63], v[96:111]
    ds_read_b64_tr_b16 v[188:189], v7 offset:4096
    s_waitcnt lgkmcnt(4)
    v_mfma_f32_32x32x16_bf16 v[96:111], v[248:251], v[64:67], v[96:111]
    ds_read_b64_tr_b16 v[190:191], v7 offset:5120
    v_mfma_f32_32x32x16_bf16 v[96:111], v[252:255], v[68:71], v[96:111]
    s_waitcnt vmcnt(0)
    s_setprio 0
    s_barrier
    s_cmp_lg_u32 s48, 0
    s_cbranch_scc1 sa_23
    v_mov_b32 v10, s3
    v_lshlrev_b32 v11, 8, v0
    s_mov_b32 exec_lo, 0x3fff
    s_mov_b32 exec_hi, 0
    buffer_store_dword v10, v11, s[40:43], s60 offen sc1
    s_mov_b64 exec, -1
sa_23:
    v_mov_b32 v44, v34
    v_mov_b32 v45, v34
    v_mov_b32 v46, v34
    s_setprio 3
    s_nop 0
    v_mfma_f32_32x32x16_bf16 v[96:111], v[40:43], v[44:47], v[96:111]
    s_setprio 0
    v_and_b32 v12, 0xffff0000, v32
    v_rcp_f32 v12, v12
    s_nop 0
    v_mul_f32 v12, 0xbeeff558, v12
    v_mul_f32 v80, v80, v12
    v_mul_f32 v81, v81, v12
    v_mul_f32 v82, v82, v12
    v_fmaak_f32 v24, v80, v80, 0x409d30fc
    v_mul_f32 v83, v83, v12
    s_add_u32 m0, s53, 0
    s_add_u32 s56, s54, 157696
    buffer_load_dwordx4 v8, s[32:35], s56 offen  lds
    v_fmaak_f32 v25, v81, v81, 0x409d30fc
    v_mul_f32 v84, v84, v12
    v_fmaak_f32 v26, v82, v82, 0x409d30fc
    v_mul_f32 v24, v24, v80
    v_mul_f32 v85, v85, v12
    s_add_u32 m0, s53, 1024
    s_add_u32 s56, s54, 164864
    buffer_load_dwordx4 v8, s[32:35], s56 offen  lds
    v_fmaak_f32 v27, v83, v83, 0x409d30fc
    v_mul_f32 v25, v25, v81
    v_mul_f32 v86, v86, v12
    v_fmaak_f32 v28, v84, v84, 0x409d30fc
    v_mul_f32 v26, v26, v82
    s_waitcnt lgkmcnt(4)
    s_add_u32 m0, s53, 2048
    s_add_u32 s56, s54, 172032
    buffer_load_dwordx4 v8, s[32:35], s56 offen  lds
    v_exp_f32 v24, v24
    v_mul_f32 v87, v87, v12
    v_fmaak_f32 v29, v85, v85, 0x409d30fc
    v_mul_f32 v27, v27, v83
    v_exp_f32 v25, v25
    s_add_u32 m0, s53, 3072
    s_add_u32 s56, s54, 179200
    buffer_load_dwordx4 v8, s[32:35], s56 offen  lds
    v_fmaak_f32 v30, v86, v86, 0x409d30fc
    v_mul_f32 v28, v28, v84
    v_exp_f32 v26, v26
    v_mul_f32 v80, v80, v88
    v_fmaak_f32 v31, v87, v87, 0x409d30fc
    s_waitcnt lgkmcnt(0)
    s_add_u32 m0, s53, 4096
    s_add_u32 s56, s54, 186368
    buffer_load_dwordx4 v8, s[32:35], s56 offen  lds
    v_mul_f32 v29, v29, v85
    v_exp_f32 v27, v27
    v_mul_f32 v81, v81, v89
    v_mul_f32 v30, v30, v86
    v_exp_f32 v28, v28
    v_mul_f32 v82, v82, v90
    s_add_u32 m0, s53, 5120
    s_add_u32 s56, s54, 193536
    buffer_load_dwordx4 v8, s[32:35], s56 offen  lds
    v_add_f32 v24, 1.0, v24
    v_mul_f32 v31, v31, v87
    v_exp_f32 v29, v29
    v_mul_f32 v83, v83, v91
    v_add_f32 v25, 1.0, v25
    v_and_b32 v22, 3, v0
    v_lshlrev_b32 v22, 3, v22
    buffer_load_dword v23, v22, s[40:43], s77 offen sc1
    buffer_load_dword v22, v22, s[40:43], s76 offen sc1
    v_exp_f32 v30, v30
    v_mul_f32 v84, v84, v92
    v_add_f32 v26, 1.0, v26
    v_rcp_f32 v24, v24
    v_exp_f32 v31, v31
    v_mul_f32 v85, v85, v93
    v_add_f32 v27, 1.0, v27
    v_rcp_f32 v25, v25
    v_mul_f32 v86, v86, v94
    v_add_f32 v28, 1.0, v28
    v_rcp_f32 v26, v26
    v_mul_f32 v87, v87, v95
    v_add_f32 v29, 1.0, v29
    v_rcp_f32 v27, v27
    v_add_f32 v30, 1.0, v30
    v_rcp_f32 v28, v28
    v_mul_f32 v80, v80, v24
    v_add_f32 v31, 1.0, v31
    v_rcp_f32 v29, v29
    v_mul_f32 v81, v81, v25
    v_rcp_f32 v30, v30
    v_mul_f32 v82, v82, v26
    v_rcp_f32 v31, v31
    v_mul_f32 v83, v83, v27
    v_mul_f32 v84, v84, v28
    v_mul_f32 v85, v85, v29
    v_mul_f32 v86, v86, v30
    v_mul_f32 v87, v87, v31
    v_cvt_pk_bf16_f32 v88, v80, v81
    v_cvt_pk_bf16_f32 v89, v82, v83
    v_cvt_pk_bf16_f32 v90, v84, v85
    v_cvt_pk_bf16_f32 v91, v86, v87
    s_add_u32 s56, s55, 229376
    buffer_store_dwordx4 v[88:91], v9, s[40:43], s56 offen sc1
    v_and_b32 v12, 0xffff0000, v34
    v_rcp_f32 v12, v12
    s_nop 0
    v_mul_f32 v12, 0xbeeff558, v12
    v_mul_f32 v96, v96, v12
    v_mul_f32 v97, v97, v12
    v_mul_f32 v98, v98, v12
    v_fmaak_f32 v24, v96, v96, 0x409d30fc
    v_mul_f32 v99, v99, v12
    v_fmaak_f32 v25, v97, v97, 0x409d30fc
    v_mul_f32 v100, v100, v12
    v_fmaak_f32 v26, v98, v98, 0x409d30fc
    v_mul_f32 v24, v24, v96
    v_mul_f32 v101, v101, v12
    v_fmaak_f32 v27, v99, v99, 0x409d30fc
    v_mul_f32 v25, v25, v97
    v_mul_f32 v102, v102, v12
    v_fmaak_f32 v28, v100, v100, 0x409d30fc
    v_mul_f32 v26, v26, v98
    v_exp_f32 v24, v24
    v_mul_f32 v103, v103, v12
    v_fmaak_f32 v29, v101, v101, 0x409d30fc
    v_mul_f32 v27, v27, v99
    v_exp_f32 v25, v25
    v_fmaak_f32 v30, v102, v102, 0x409d30fc
    v_mul_f32 v28, v28, v100
    v_exp_f32 v26, v26
    v_mul_f32 v96, v96, v104
    s_barrier
    buffer_load_dword v21, v20, s[40:43], s74 offen sc1
    v_fmaak_f32 v31, v103, v103, 0x409d30fc
    v_mul_f32 v29, v29, v101
    v_exp_f32 v27, v27
    v_mul_f32 v97, v97, v105
    v_mul_f32 v30, v30, v102
    v_exp_f32 v28, v28
    v_mul_f32 v98, v98, v106
    v_add_f32 v24, 1.0, v24
    v_mul_f32 v31, v31, v103
    v_exp_f32 v29, v29
    v_mul_f32 v99, v99, v107
    v_add_f32 v25, 1.0, v25
    v_exp_f32 v30, v30
    v_mul_f32 v100, v100, v108
    v_add_f32 v26, 1.0, v26
    v_rcp_f32 v24, v24
    v_exp_f32 v31, v31
    v_mul_f32 v101, v101, v109
    v_add_f32 v27, 1.0, v27
    v_rcp_f32 v25, v25
    v_mul_f32 v102, v102, v110
    v_add_f32 v28, 1.0, v28
    v_rcp_f32 v26, v26
    v_mul_f32 v103, v103, v111
    v_add_f32 v29, 1.0, v29
    v_rcp_f32 v27, v27
    v_add_f32 v30, 1.0, v30
    v_rcp_f32 v28, v28
    v_mul_f32 v96, v96, v24
    v_add_f32 v31, 1.0, v31
    v_rcp_f32 v29, v29
    v_mul_f32 v97, v97, v25
    v_rcp_f32 v30, v30
    v_mul_f32 v98, v98, v26
    v_rcp_f32 v31, v31
    v_mul_f32 v99, v99, v27
    v_mul_f32 v100, v100, v28
    v_mul_f32 v101, v101, v29
    v_mul_f32 v102, v102, v30
    v_mul_f32 v103, v103, v31
    v_cvt_pk_bf16_f32 v104, v96, v97
    v_cvt_pk_bf16_f32 v105, v98, v99
    v_cvt_pk_bf16_f32 v106, v100, v101
    v_cvt_pk_bf16_f32 v107, v102, v103
    s_add_u32 s56, s55, 344064
    buffer_store_dwordx4 v[104:107], v9, s[40:43], s56 offen sc1
    s_setprio 0
    s_waitcnt vmcnt(1)
    s_mov_b32 s57, 0
poll_24:
    v_cmp_ne_u32 s[64:65], s3, v21
    s_cmp_eq_u64 s[64:65], 0
    s_cbranch_scc1 pd_25
    s_add_u32 s57, s57, 1
    s_cmp_gt_u32 s57, 0x40000
    s_cbranch_scc1 pd_25
    s_mov_b64 exec, s[64:65]
    s_cbranch_execz ps_26
    buffer_load_dword v21, v20, s[40:43], s74 offen sc1
ps_26:
    s_mov_b64 exec, -1
    s_waitcnt vmcnt(0)
    s_branch poll_24
pd_25:
    s_add_u32 s58, s73, 0
    buffer_load_dwordx4 v[56:59], v9, s[40:43], s58 offen offset:0 sc1
    buffer_load_dwordx4 v[60:63], v9, s[40:43], s58 offen offset:1024 sc1
    buffer_load_dwordx4 v[64:67], v9, s[40:43], s58 offen offset:2048 sc1
    v_mov_b32 v2, v36
    v_mov_b32 v3, v37
    v_mov_b32 v4, v38
    v_mov_b32 v5, v39
    v_and_b32 v22, 0xffff0000, v22
    v_mul_f32 v22, 0xbeeff558, v22
    v_rcp_f32 v22, v22
    v_and_b32 v23, 0xffff0000, v23
    v_mul_f32 v23, 0xbeeff558, v23
    v_rcp_f32 v23, v23
    s_add_u32 s60, s60, 65536
    s_add_u32 s74, s74, 65536
    s_mov_b32 s79, 4294918144
    s_cmp_ge_u32 s48, 6
    s_cselect_b32 s79, 16384, s79
    ds_read_b64_tr_b16 v[192:193], v6 offset:0
    ds_read_b64_tr_b16 v[194:195], v6 offset:1024
    ds_read_b64_tr_b16 v[196:197], v7 offset:0
    ds_read_b64_tr_b16 v[198:199], v7 offset:1024
    ds_read_b64_tr_b16 v[200:201], v6 offset:2048
    ds_read_b64_tr_b16 v[202:203], v6 offset:3072
    ds_read_b64_tr_b16 v[204:205], v7 offset:2048
    ds_read_b64_tr_b16 v[206:207], v7 offset:3072
    ds_read_b64_tr_b16 v[208:209], v6 offset:4096
    ds_read_b64_tr_b16 v[210:211], v6 offset:5120
    ds_read_b64_tr_b16 v[212:213], v7 offset:4096
    ds_read_b64_tr_b16 v[214:215], v7 offset:5120
    s_waitcnt vmcnt(3)
    s_barrier
    s_cmp_lg_u32 s48, 0
    s_cbranch_scc1 sb_27
    v_mov_b32 v10, s3
    v_lshlrev_b32 v11, 8, v0
    s_mov_b32 exec_lo, 0x3fff
    s_mov_b32 exec_hi, 0
    buffer_store_dword v10, v11, s[40:43], s60 offen sc1
    s_mov_b64 exec, -1
    s_cmp_lg_u32 s2, 0
    s_cbranch_scc1 sb_27
    s_mov_b32 s56, 1998848
    v_mov_b32 v10, s3
    s_mov_b64 exec, 1
    buffer_store_dword v10, off, s[40:43], s56 sc1
    s_mov_b64 exec, -1
sb_27:
    buffer_load_dwordx4 v[68:71], v9, s[40:43], s58 offen offset:3072 sc1
    s_add_u32 s58, s73, 4096
    buffer_load_dwordx4 v[72:75], v9, s[40:43], s58 offen offset:0 sc1
    buffer_load_dwordx4 v[76:79], v9, s[40:43], s58 offen offset:1024 sc1
    buffer_load_dwordx4 v[216:219], v9, s[40:43], s58 offen offset:2048 sc1
    buffer_load_dwordx4 v[220:223], v9, s[40:43], s58 offen offset:3072 sc1
    s_add_u32 s58, s73, 8192
    buffer_load_dwordx4 v[24:27], v9, s[40:43], s58 offen offset:0 sc1
    s_waitcnt vmcnt(8)
    v_mfma_f32_32x32x16_bf16 v[80:95], v[112:115], v[56:59], 0
    v_mfma_f32_32x32x16_bf16 v[96:111], v[116:119], v[56:59], 0
    buffer_load_dwordx4 v[28:31], v9, s[40:43], s58 offen offset:1024 sc1
    s_waitcnt vmcnt(8)
    v_mfma_f32_32x32x16_bf16 v[80:95], v[120:123], v[60:63], v[80:95]
    v_mfma_f32_32x32x16_bf16 v[96:111], v[124:127], v[60:63], v[96:111]
    buffer_load_dwordx4 v[32:35], v9, s[40:43], s58 offen offset:2048 sc1
    s_waitcnt vmcnt(8)
    v_mfma_f32_32x32x16_bf16 v[80:95], v[128:131], v[64:67], v[80:95]
    v_mfma_f32_32x32x16_bf16 v[96:111], v[132:135], v[64:67], v[96:111]
    buffer_load_dwordx4 v[36:39], v9, s[40:43], s58 offen offset:3072 sc1
    s_waitcnt vmcnt(8)
    v_mfma_f32_32x32x16_bf16 v[80:95], v[136:139], v[68:71], v[80:95]
    v_mfma_f32_32x32x16_bf16 v[96:111], v[140:143], v[68:71], v[96:111]
    s_add_u32 s58, s73, 12288
    buffer_load_dwordx4 v[40:43], v9, s[40:43], s58 offen offset:0 sc1
    s_waitcnt vmcnt(8)
    v_mfma_f32_32x32x16_bf16 v[80:95], v[48:51], v[72:75], v[80:95]
    v_mfma_f32_32x32x16_bf16 v[96:111], v[52:55], v[72:75], v[96:111]
    buffer_load_dwordx4 v[44:47], v9, s[40:43], s58 offen offset:1024 sc1
    s_waitcnt vmcnt(8)
    v_mfma_f32_32x32x16_bf16 v[80:95], v[144:147], v[76:79], v[80:95]
    v_mfma_f32_32x32x16_bf16 v[96:111], v[148:151], v[76:79], v[96:111]
    s_waitcnt vmcnt(7)
    v_mfma_f32_32x32x16_bf16 v[80:95], v[152:155], v[216:219], v[80:95]
    v_mfma_f32_32x32x16_bf16 v[96:111], v[156:159], v[216:219], v[96:111]
    buffer_load_dword v21, v20, s[40:43], s74 offen sc1
    s_waitcnt vmcnt(7)
    v_mfma_f32_32x32x16_bf16 v[80:95], v[160:163], v[220:223], v[80:95]
    v_mfma_f32_32x32x16_bf16 v[96:111], v[164:167], v[220:223], v[96:111]
    s_waitcnt vmcnt(6)
    v_mfma_f32_32x32x16_bf16 v[80:95], v[168:171], v[24:27], v[80:95]
    v_mfma_f32_32x32x16_bf16 v[96:111], v[172:175], v[24:27], v[96:111]
    s_waitcnt vmcnt(5)
    v_mfma_f32_32x32x16_bf16 v[80:95], v[176:179], v[28:31], v[80:95]
    v_mfma_f32_32x32x16_bf16 v[96:111], v[180:183], v[28:31], v[96:111]
    s_waitcnt vmcnt(0)
    s_mov_b32 s57, 0
poll_28:
    v_cmp_ne_u32 s[64:65], s3, v21
    s_cmp_eq_u64 s[64:65], 0
    s_cbranch_scc1 pd_29
    s_add_u32 s57, s57, 1
    s_cmp_gt_u32 s57, 0x40000
    s_cbranch_scc1 pd_29
    s_mov_b64 exec, s[64:65]
    s_cbranch_execz ps_30
    buffer_load_dword v21, v20, s[40:43], s74 offen sc1
ps_30:
    s_mov_b64 exec, -1
    s_waitcnt vmcnt(0)
    s_branch poll_28
pd_29:
    s_add_u32 s58, s73, 229376
    buffer_load_dwordx4 v[56:59], v9, s[40:43], s58 offen offset:0 sc1
    buffer_load_dwordx4 v[60:63], v9, s[40:43], s58 offen offset:1024 sc1
    buffer_load_dwordx4 v[64:67], v9, s[40:43], s58 offen offset:2048 sc1
    v_mfma_f32_32x32x16_bf16 v[80:95], v[184:187], v[32:35], v[80:95]
    v_mfma_f32_32x32x16_bf16 v[96:111], v[188:191], v[32:35], v[96:111]
    buffer_load_dwordx4 v[68:71], v9, s[40:43], s58 offen offset:3072 sc1
    s_add_u32 s58, s73, 233472
    buffer_load_dwordx4 v[72:75], v9, s[40:43], s58 offen offset:0 sc1
    buffer_load_dwordx4 v[76:79], v9, s[40:43], s58 offen offset:1024 sc1
    s_waitcnt lgkmcnt(8)
    v_mfma_f32_32x32x16_bf16 v[80:95], v[192:195], v[36:39], v[80:95]
    v_mfma_f32_32x32x16_bf16 v[96:111], v[196:199], v[36:39], v[96:111]
    buffer_load_dwordx4 v[216:219], v9, s[40:43], s58 offen offset:2048 sc1
    buffer_load_dwordx4 v[220:223], v9, s[40:43], s58 offen offset:3072 sc1
    s_add_u32 s58, s73, 237568
    buffer_load_dwordx4 v[24:27], v9, s[40:43], s58 offen offset:0 sc1
    s_waitcnt lgkmcnt(4)
    v_mfma_f32_32x32x16_bf16 v[80:95], v[200:203], v[40:43], v[80:95]
    v_mfma_f32_32x32x16_bf16 v[96:111], v[204:207], v[40:43], v[96:111]
    buffer_load_dwordx4 v[28:31], v9, s[40:43], s58 offen offset:1024 sc1
    buffer_load_dwordx4 v[32:35], v9, s[40:43], s58 offen offset:2048 sc1
    buffer_load_dwordx4 v[36:39], v9, s[40:43], s58 offen offset:3072 sc1
    s_waitcnt lgkmcnt(0)
    v_mfma_f32_32x32x16_bf16 v[80:95], v[208:211], v[44:47], v[80:95]
    v_mfma_f32_32x32x16_bf16 v[96:111], v[212:215], v[44:47], v[96:111]
    s_add_u32 s58, s73, 241664
    buffer_load_dwordx4 v[40:43], v9, s[40:43], s58 offen offset:0 sc1
    buffer_load_dwordx4 v[44:47], v9, s[40:43], s58 offen offset:1024 sc1
    s_waitcnt vmcnt(13)
    v_mfma_f32_32x32x16_bf16 v[224:239], v[112:115], v[56:59], 0
    v_mfma_f32_32x32x16_bf16 v[240:255], v[116:119], v[56:59], 0
    s_waitcnt vmcnt(12)
    v_mfma_f32_32x32x16_bf16 v[224:239], v[120:123], v[60:63], v[224:239]
    v_mfma_f32_32x32x16_bf16 v[240:255], v[124:127], v[60:63], v[240:255]
    s_waitcnt vmcnt(11)
    v_mfma_f32_32x32x16_bf16 v[224:239], v[128:131], v[64:67], v[224:239]
    v_mfma_f32_32x32x16_bf16 v[240:255], v[132:135], v[64:67], v[240:255]
    s_waitcnt vmcnt(10)
    v_mfma_f32_32x32x16_bf16 v[224:239], v[136:139], v[68:71], v[224:239]
    ds_write_b128 v13, v[80:83] offset:0
    v_mfma_f32_32x32x16_bf16 v[240:255], v[140:143], v[68:71], v[240:255]
    ds_write_b128 v14, v[84:87] offset:1024
    s_waitcnt vmcnt(9)
    v_mfma_f32_32x32x16_bf16 v[224:239], v[48:51], v[72:75], v[224:239]
    ds_write_b128 v15, v[88:91] offset:2048
    v_mfma_f32_32x32x16_bf16 v[240:255], v[52:55], v[72:75], v[240:255]
    ds_write_b128 v16, v[92:95] offset:3072
    s_waitcnt vmcnt(8)
    v_mfma_f32_32x32x16_bf16 v[224:239], v[144:147], v[76:79], v[224:239]
    ds_write_b128 v13, v[96:99] offset:4096
    v_mfma_f32_32x32x16_bf16 v[240:255], v[148:151], v[76:79], v[240:255]
    ds_write_b128 v14, v[100:103] offset:5120
    s_waitcnt vmcnt(7)
    v_mfma_f32_32x32x16_bf16 v[224:239], v[152:155], v[216:219], v[224:239]
    ds_write_b128 v15, v[104:107] offset:6144
    v_mfma_f32_32x32x16_bf16 v[240:255], v[156:159], v[216:219], v[240:255]
    ds_write_b128 v16, v[108:111] offset:7168
    s_waitcnt vmcnt(6)
    v_mfma_f32_32x32x16_bf16 v[224:239], v[160:163], v[220:223], v[224:239]
    v_add_u32 v13, s79, v13
    v_add_u32 v14, s79, v14
    v_add_u32 v15, s79, v15
    v_add_u32 v16, s79, v16
    v_mfma_f32_32x32x16_bf16 v[240:255], v[164:167], v[220:223], v[240:255]
    s_waitcnt lgkmcnt(0)
    s_barrier
    ds_read_b128 v[80:83], v18 offset:0
    ds_read_b128 v[84:87], v18 offset:8192
    ds_read_b128 v[88:91], v18 offset:16384
    ds_read_b128 v[92:95], v18 offset:24576
    s_waitcnt vmcnt(5)
    v_mfma_f32_32x32x16_bf16 v[224:239], v[168:171], v[24:27], v[224:239]
    ds_read_b128 v[96:99], v18 offset:32768
    ds_read_b128 v[100:103], v18 offset:40960
    ds_read_b128 v[104:107], v18 offset:49152
    ds_read_b128 v[108:111], v18 offset:57344
    v_mfma_f32_32x32x16_bf16 v[240:255], v[172:175], v[24:27], v[240:255]
    s_waitcnt vmcnt(4)
    v_mfma_f32_32x32x16_bf16 v[224:239], v[176:179], v[28:31], v[224:239]
    s_waitcnt lgkmcnt(6)
    v_add_f32 v80, v80, v84
    v_add_f32 v81, v81, v85
    v_add_f32 v82, v82, v86
    v_add_f32 v83, v83, v87
    s_waitcnt lgkmcnt(5)
    v_add_f32 v80, v80, v88
    v_add_f32 v81, v81, v89
    v_add_f32 v82, v82, v90
    v_add_f32 v83, v83, v91
    v_mfma_f32_32x32x16_bf16 v[240:255], v[180:183], v[28:31], v[240:255]
    v_lshlrev_b32 v88, 16, v2
    v_and_b32 v89, 0xffff0000, v2
    v_lshlrev_b32 v90, 16, v3
    v_and_b32 v91, 0xffff0000, v3
    s_waitcnt lgkmcnt(4)
    v_add_f32 v80, v80, v92
    v_add_f32 v81, v81, v93
    v_add_f32 v82, v82, v94
    v_add_f32 v83, v83, v95
    s_waitcnt vmcnt(3)
    v_mfma_f32_32x32x16_bf16 v[224:239], v[184:187], v[32:35], v[224:239]
    s_waitcnt lgkmcnt(3)
    v_add_f32 v80, v80, v96
    v_add_f32 v81, v81, v97
    v_add_f32 v82, v82, v98
    v_add_f32 v83, v83, v99
    v_mfma_f32_32x32x16_bf16 v[240:255], v[188:191], v[32:35], v[240:255]
    s_waitcnt lgkmcnt(2)
    v_add_f32 v80, v80, v100
    v_add_f32 v81, v81, v101
    v_add_f32 v82, v82, v102
    v_add_f32 v83, v83, v103
    s_waitcnt lgkmcnt(1)
    v_add_f32 v80, v80, v104
    v_add_f32 v81, v81, v105
    v_add_f32 v82, v82, v106
    v_add_f32 v83, v83, v107
    s_waitcnt vmcnt(2)
    v_mfma_f32_32x32x16_bf16 v[224:239], v[192:195], v[36:39], v[224:239]
    s_waitcnt lgkmcnt(0)
    v_add_f32 v80, v80, v108
    v_add_f32 v81, v81, v109
    v_add_f32 v82, v82, v110
    v_add_f32 v83, v83, v111
    v_mfma_f32_32x32x16_bf16 v[240:255], v[196:199], v[36:39], v[240:255]
    v_mul_f32 v80, v80, v22
    v_mul_f32 v81, v81, v22
    v_mul_f32 v82, v82, v22
    v_mul_f32 v83, v83, v22
    v_cvt_pk_bf16_f32 v84, v80, v81
    v_cvt_pk_bf16_f32 v85, v82, v83
    s_waitcnt vmcnt(1)
    v_mfma_f32_32x32x16_bf16 v[224:239], v[200:203], v[40:43], v[224:239]
    v_lshlrev_b32 v80, 16, v84
    v_and_b32 v81, 0xffff0000, v84
    v_lshlrev_b32 v82, 16, v85
    v_and_b32 v83, 0xffff0000, v85
    v_mfma_f32_32x32x16_bf16 v[240:255], v[204:207], v[40:43], v[240:255]
    v_add_f32 v80, v80, v88
    v_add_f32 v81, v81, v89
    v_add_f32 v82, v82, v90
    v_add_f32 v83, v83, v91
    v_cvt_pk_bf16_f32 v86, v80, v81
    v_cvt_pk_bf16_f32 v87, v82, v83
    s_waitcnt vmcnt(0)
    v_mfma_f32_32x32x16_bf16 v[224:239], v[208:211], v[44:47], v[224:239]
    buffer_store_dwordx2 v[86:87], v19, s[36:39], s61 offen sc1
    v_mfma_f32_32x32x16_bf16 v[240:255], v[212:215], v[44:47], v[240:255]
    v_add_u32 v18, 114688, v17
    s_nop 7
    s_nop 1
    ds_write_b128 v13, v[224:227] offset:0
    ds_write_b128 v14, v[228:231] offset:1024
    ds_write_b128 v15, v[232:235] offset:2048
    ds_write_b128 v16, v[236:239] offset:3072
    ds_write_b128 v13, v[240:243] offset:4096
    ds_write_b128 v14, v[244:247] offset:5120
    ds_write_b128 v15, v[248:251] offset:6144
    ds_write_b128 v16, v[252:255] offset:7168
    s_waitcnt lgkmcnt(0)
    s_barrier
    ds_read_b128 v[224:227], v17 offset:0
    ds_read_b128 v[228:231], v17 offset:8192
    ds_read_b128 v[232:235], v17 offset:16384
    ds_read_b128 v[236:239], v17 offset:24576
    ds_read_b128 v[240:243], v17 offset:32768
    ds_read_b128 v[244:247], v17 offset:40960
    ds_read_b128 v[248:251], v18 offset:0
    ds_read_b128 v[252:255], v18 offset:8192
    s_waitcnt lgkmcnt(6)
    v_add_f32 v224, v224, v228
    v_add_f32 v225, v225, v229
    v_add_f32 v226, v226, v230
    v_add_f32 v227, v227, v231
    s_waitcnt lgkmcnt(5)
    v_add_f32 v224, v224, v232
    v_add_f32 v225, v225, v233
    v_add_f32 v226, v226, v234
    v_add_f32 v227, v227, v235
    v_lshlrev_b32 v232, 16, v4
    v_and_b32 v233, 0xffff0000, v4
    v_lshlrev_b32 v234, 16, v5
    v_and_b32 v235, 0xffff0000, v5
    s_waitcnt lgkmcnt(4)
    v_add_f32 v224, v224, v236
    v_add_f32 v225, v225, v237
    v_add_f32 v226, v226, v238
    v_add_f32 v227, v227, v239
    s_waitcnt lgkmcnt(3)
    v_add_f32 v224, v224, v240
    v_add_f32 v225, v225, v241
    v_add_f32 v226, v226, v242
    v_add_f32 v227, v227, v243
    s_waitcnt lgkmcnt(2)
    v_add_f32 v224, v224, v244
    v_add_f32 v225, v225, v245
    v_add_f32 v226, v226, v246
    v_add_f32 v227, v227, v247
    s_waitcnt lgkmcnt(1)
    v_add_f32 v224, v224, v248
    v_add_f32 v225, v225, v249
    v_add_f32 v226, v226, v250
    v_add_f32 v227, v227, v251
    s_waitcnt lgkmcnt(0)
    v_add_f32 v224, v224, v252
    v_add_f32 v225, v225, v253
    v_add_f32 v226, v226, v254
    v_add_f32 v227, v227, v255
    v_mul_f32 v224, v224, v23
    v_mul_f32 v225, v225, v23
    v_mul_f32 v226, v226, v23
    v_mul_f32 v227, v227, v23
    v_cvt_pk_bf16_f32 v228, v224, v225
    v_cvt_pk_bf16_f32 v229, v226, v227
    v_lshlrev_b32 v224, 16, v228
    v_and_b32 v225, 0xffff0000, v228
    v_lshlrev_b32 v226, 16, v229
    v_and_b32 v227, 0xffff0000, v229
    v_add_f32 v224, v224, v232
    v_add_f32 v225, v225, v233
    v_add_f32 v226, v226, v234
    v_add_f32 v227, v227, v235
    v_cvt_pk_bf16_f32 v230, v224, v225
    v_cvt_pk_bf16_f32 v231, v226, v227
    s_add_u32 s61, s61, 917504
    buffer_store_dwordx2 v[230:231], v19, s[36:39], s61 offen
    s_branch L_fin
grpB_18:
    s_waitcnt vmcnt(2)
    s_mov_b32 s57, 0
gw_31:
    v_cmp_eq_u32 vcc, s3, v23
    s_cbranch_vccnz gw_32
    s_add_u32 s57, s57, 1
    s_cmp_gt_u32 s57, 0x40000
    s_cbranch_scc1 gw_32
    s_sleep 1
    s_and_b32 s56, s57, 3
    s_cmp_eq_u32 s56, 0
    s_cselect_b32 exec_lo, 3, 2
    s_mov_b32 exec_hi, 0
    buffer_load_dword v23, v22, s[40:43], s72 offen sc1
    s_mov_b64 exec, -1
    s_waitcnt vmcnt(0)
    s_branch gw_31
gw_32:
    s_add_u32 m0, s50, 57344
    s_add_u32 s56, s51, 917504
    buffer_load_dwordx4 v10, s[40:43], s56 offen sc1 lds
    s_add_u32 m0, s50, 53248
    s_add_u32 s56, s51, 913408
    buffer_load_dwordx4 v10, s[40:43], s56 offen sc1 lds
    s_add_u32 m0, s50, 65536
    s_add_u32 s56, s51, 925696
    buffer_load_dwordx4 v10, s[40:43], s56 offen sc1 lds
    s_add_u32 m0, s50, 61440
    s_add_u32 s56, s51, 921600
    buffer_load_dwordx4 v10, s[40:43], s56 offen sc1 lds
    s_add_u32 m0, s50, 73728
    s_add_u32 s56, s51, 933888
    buffer_load_dwordx4 v10, s[40:43], s56 offen sc1 lds
    s_add_u32 m0, s50, 69632
    s_add_u32 s56, s51, 929792
    buffer_load_dwordx4 v10, s[40:43], s56 offen sc1 lds
    s_waitcnt vmcnt(6)
    v_cmp_ne_u32 vcc, s3, v33
    v_cmp_ne_u32 s[62:63], s3, v35
    s_or_b64 vcc, vcc, s[62:63]
    s_mov_b32 s57, 0
    s_cbranch_vccz gro_34
grp_33:
    buffer_load_dwordx2 v[32:33], v11, s[40:43], s58 offen offset:0 sc1
    buffer_load_dwordx2 v[34:35], v11, s[40:43], s58 offen offset:256 sc1
    s_add_u32 s57, s57, 1
    s_cmp_gt_u32 s57, 0x40000
    s_cbranch_scc1 gro_34
    s_waitcnt vmcnt(0)
    v_cmp_ne_u32 vcc, s3, v33
    v_cmp_ne_u32 s[62:63], s3, v35
    s_or_b64 vcc, vcc, s[62:63]
    s_cbranch_vccnz grp_33
gro_34:
    v_mov_b32 v44, v32
    v_mov_b32 v45, v32
    v_mov_b32 v46, v32
    v_and_b32 v12, 0xffff0000, v32
    v_rcp_f32 v12, v12
    s_setprio 3
    v_mfma_f32_32x32x16_bf16 v[80:95], v[40:43], v[44:47], v[80:95]
    s_setprio 0
    v_mul_f32 v12, 0xbeeff558, v12
    s_add_u32 m0, s50, 81920
    s_add_u32 s56, s51, 942080
    buffer_load_dwordx4 v10, s[40:43], s56 offen sc1 lds
    s_add_u32 m0, s50, 77824
    s_add_u32 s56, s51, 937984
    buffer_load_dwordx4 v10, s[40:43], s56 offen sc1 lds
    s_add_u32 m0, s50, 90112
    s_add_u32 s56, s51, 950272
    buffer_load_dwordx4 v10, s[40:43], s56 offen sc1 lds
    s_add_u32 m0, s50, 86016
    s_add_u32 s56, s51, 946176
    buffer_load_dwordx4 v10, s[40:43], s56 offen sc1 lds
    v_mul_f32 v80, v80, v12
    v_mul_f32 v81, v81, v12
    v_mul_f32 v82, v82, v12
    v_fmaak_f32 v24, v80, v80, 0x409d30fc
    v_mul_f32 v83, v83, v12
    v_fmaak_f32 v25, v81, v81, 0x409d30fc
    v_mul_f32 v84, v84, v12
    v_fmaak_f32 v26, v82, v82, 0x409d30fc
    v_mul_f32 v24, v24, v80
    v_mul_f32 v85, v85, v12
    v_fmaak_f32 v27, v83, v83, 0x409d30fc
    v_mul_f32 v25, v25, v81
    s_add_u32 m0, s50, 98304
    s_add_u32 s56, s51, 958464
    buffer_load_dwordx4 v10, s[40:43], s56 offen sc1 lds
    v_mul_f32 v86, v86, v12
    v_fmaak_f32 v28, v84, v84, 0x409d30fc
    v_mul_f32 v26, v26, v82
    v_exp_f32 v24, v24
    v_mul_f32 v87, v87, v12
    v_fmaak_f32 v29, v85, v85, 0x409d30fc
    v_mul_f32 v27, v27, v83
    v_exp_f32 v25, v25
    v_fmaak_f32 v30, v86, v86, 0x409d30fc
    v_mul_f32 v28, v28, v84
    v_exp_f32 v26, v26
    v_mul_f32 v80, v80, v88
    s_add_u32 m0, s50, 94208
    s_add_u32 s56, s51, 954368
    buffer_load_dwordx4 v10, s[40:43], s56 offen sc1 lds
    v_fmaak_f32 v31, v87, v87, 0x409d30fc
    v_mul_f32 v29, v29, v85
    v_exp_f32 v27, v27
    v_mul_f32 v81, v81, v89
    v_mul_f32 v30, v30, v86
    v_exp_f32 v28, v28
    v_mul_f32 v82, v82, v90
    v_add_f32 v24, 1.0, v24
    v_mul_f32 v31, v31, v87
    v_exp_f32 v29, v29
    v_mul_f32 v83, v83, v91
    v_add_f32 v25, 1.0, v25
    v_exp_f32 v30, v30
    s_add_u32 m0, s50, 106496
    s_add_u32 s56, s51, 966656
    buffer_load_dwordx4 v10, s[40:43], s56 offen sc1 lds
    v_mul_f32 v84, v84, v92
    v_add_f32 v26, 1.0, v26
    v_rcp_f32 v24, v24
    v_exp_f32 v31, v31
    v_mul_f32 v85, v85, v93
    v_add_f32 v27, 1.0, v27
    v_rcp_f32 v25, v25
    v_mul_f32 v86, v86, v94
    v_add_f32 v28, 1.0, v28
    v_rcp_f32 v26, v26
    v_mul_f32 v87, v87, v95
    v_add_f32 v29, 1.0, v29
    s_add_u32 m0, s50, 102400
    s_add_u32 s56, s51, 962560
    buffer_load_dwordx4 v10, s[40:43], s56 offen sc1 lds
    v_rcp_f32 v27, v27
    v_add_f32 v30, 1.0, v30
    v_rcp_f32 v28, v28
    v_mul_f32 v80, v80, v24
    v_add_f32 v31, 1.0, v31
    v_rcp_f32 v29, v29
    v_mul_f32 v81, v81, v25
    v_rcp_f32 v30, v30
    v_mul_f32 v82, v82, v26
    v_rcp_f32 v31, v31
    v_mul_f32 v83, v83, v27
    v_mul_f32 v84, v84, v28
    v_mul_f32 v85, v85, v29
    v_mul_f32 v86, v86, v30
    v_mul_f32 v87, v87, v31
    v_cvt_pk_bf16_f32 v88, v80, v81
    v_cvt_pk_bf16_f32 v89, v82, v83
    v_cvt_pk_bf16_f32 v90, v84, v85
    v_cvt_pk_bf16_f32 v91, v86, v87
    s_add_u32 s56, s55, 0
    buffer_store_dwordx4 v[88:91], v9, s[40:43], s56 offen sc1
    v_mov_b32 v44, v34
    v_mov_b32 v45, v34
    v_mov_b32 v46, v34
    s_barrier
    s_setprio 1
    s_waitcnt lgkmcnt(7)
    v_mfma_f32_32x32x16_bf16 v[96:111], v[144:147], v[72:75], 0
    ds_read_b64_tr_b16 v[68:69], v3 offset:10240
    ds_read_b64_tr_b16 v[70:71], v3 offset:10752
    v_mfma_f32_32x32x16_bf16 v[96:111], v[148:151], v[76:79], v[96:111]
    ds_read_b64_tr_b16 v[72:73], v3 offset:12288
    ds_read_b64_tr_b16 v[74:75], v3 offset:12800
    s_waitcnt lgkmcnt(7)
    v_mfma_f32_32x32x16_bf16 v[96:111], v[152:155], v[56:59], v[96:111]
    ds_read_b64_tr_b16 v[76:77], v3 offset:14336
    ds_read_b64_tr_b16 v[78:79], v3 offset:14848
    v_mfma_f32_32x32x16_bf16 v[96:111], v[156:159], v[60:63], v[96:111]
    ds_read_b64_tr_b16 v[56:57], v3 offset:16384
    ds_read_b64_tr_b16 v[58:59], v3 offset:16896
    s_waitcnt lgkmcnt(6)
    v_mfma_f32_32x32x16_bf16 v[96:111], v[160:163], v[64:67], v[96:111]
    ds_read_b64_tr_b16 v[60:61], v3 offset:18432
    ds_read_b64_tr_b16 v[62:63], v3 offset:18944
    ds_read_b64_tr_b16 v[112:113], v6 offset:0
    v_mfma_f32_32x32x16_bf16 v[96:111], v[164:167], v[68:71], v[96:111]
    ds_read_b64_tr_b16 v[64:65], v3 offset:20480
    ds_read_b64_tr_b16 v[66:67], v3 offset:20992
    s_waitcnt lgkmcnt(7)
    v_mfma_f32_32x32x16_bf16 v[96:111], v[168:171], v[72:75], v[96:111]
    ds_read_b64_tr_b16 v[68:69], v3 offset:22528
    ds_read_b64_tr_b16 v[70:71], v3 offset:23040
    ds_read_b64_tr_b16 v[114:115], v6 offset:1024
    v_mfma_f32_32x32x16_bf16 v[96:111], v[172:175], v[76:79], v[96:111]
    ds_read_b64_tr_b16 v[72:73], v3 offset:24576
    ds_read_b64_tr_b16 v[74:75], v3 offset:25088
    s_waitcnt lgkmcnt(8)
    v_mfma_f32_32x32x16_bf16 v[96:111], v[176:179], v[56:59], v[96:111]
    ds_read_b64_tr_b16 v[76:77], v3 offset:26624
    ds_read_b64_tr_b16 v[78:79], v3 offset:27136
    ds_read_b64_tr_b16 v[116:117], v7 offset:0
    v_mfma_f32_32x32x16_bf16 v[96:111], v[180:183], v[60:63], v[96:111]
    ds_read_b64_tr_b16 v[56:57], v3 offset:28672
    ds_read_b64_tr_b16 v[58:59], v3 offset:29184
    s_waitcnt lgkmcnt(8)
    v_mfma_f32_32x32x16_bf16 v[96:111], v[184:187], v[64:67], v[96:111]
    ds_read_b64_tr_b16 v[60:61], v3 offset:30720
    ds_read_b64_tr_b16 v[62:63], v3 offset:31232
    ds_read_b64_tr_b16 v[118:119], v7 offset:1024
    v_mfma_f32_32x32x16_bf16 v[96:111], v[188:191], v[68:71], v[96:111]
    ds_read_b64_tr_b16 v[64:65], v3 offset:32768
    ds_read_b64_tr_b16 v[66:67], v3 offset:33280
    s_waitcnt lgkmcnt(8)
    v_mfma_f32_32x32x16_bf16 v[96:111], v[192:195], v[72:75], v[96:111]
    ds_read_b64_tr_b16 v[68:69], v3 offset:34816
    ds_read_b64_tr_b16 v[70:71], v3 offset:35328
    ds_read_b64_tr_b16 v[120:121], v6 offset:2048
    v_mfma_f32_32x32x16_bf16 v[96:111], v[196:199], v[76:79], v[96:111]
    ds_read_b64_tr_b16 v[72:73], v3 offset:36864
    ds_read_b64_tr_b16 v[74:75], v3 offset:37376
    s_waitcnt lgkmcnt(8)
    v_mfma_f32_32x32x16_bf16 v[96:111], v[200:203], v[56:59], v[96:111]
    ds_read_b64_tr_b16 v[76:77], v3 offset:38912
    ds_read_b64_tr_b16 v[78:79], v3 offset:39424
    ds_read_b64_tr_b16 v[122:123], v6 offset:3072
    v_mfma_f32_32x32x16_bf16 v[96:111], v[204:207], v[60:63], v[96:111]
    ds_read_b64_tr_b16 v[56:57], v3 offset:40960
    ds_read_b64_tr_b16 v[58:59], v3 offset:41472
    s_waitcnt lgkmcnt(8)
    v_mfma_f32_32x32x16_bf16 v[96:111], v[208:211], v[64:67], v[96:111]
    ds_read_b64_tr_b16 v[60:61], v3 offset:43008
    ds_read_b64_tr_b16 v[62:63], v3 offset:43520
    ds_read_b64_tr_b16 v[124:125], v7 offset:2048
    v_mfma_f32_32x32x16_bf16 v[96:111], v[212:215], v[68:71], v[96:111]
    ds_read_b64_tr_b16 v[64:65], v3 offset:45056
    ds_read_b64_tr_b16 v[66:67], v3 offset:45568
    s_waitcnt lgkmcnt(8)
    v_mfma_f32_32x32x16_bf16 v[96:111], v[216:219], v[72:75], v[96:111]
    ds_read_b64_tr_b16 v[68:69], v3 offset:47104
    ds_read_b64_tr_b16 v[70:71], v3 offset:47616
    ds_read_b64_tr_b16 v[126:127], v7 offset:3072
    v_mfma_f32_32x32x16_bf16 v[96:111], v[220:223], v[76:79], v[96:111]
    ds_read_b64_tr_b16 v[72:73], v3 offset:49152
    ds_read_b64_tr_b16 v[74:75], v3 offset:49664
    s_waitcnt lgkmcnt(8)
    v_mfma_f32_32x32x16_bf16 v[96:111], v[224:227], v[56:59], v[96:111]
    ds_read_b64_tr_b16 v[76:77], v3 offset:51200
    ds_read_b64_tr_b16 v[78:79], v3 offset:51712
    ds_read_b64_tr_b16 v[128:129], v6 offset:4096
    v_mfma_f32_32x32x16_bf16 v[96:111], v[228:231], v[60:63], v[96:111]
    ds_read_b64_tr_b16 v[56:57], v3 offset:53248
    ds_read_b64_tr_b16 v[58:59], v3 offset:53760
    s_waitcnt lgkmcnt(8)
    v_mfma_f32_32x32x16_bf16 v[96:111], v[232:235], v[64:67], v[96:111]
    ds_read_b64_tr_b16 v[60:61], v3 offset:55296
    ds_read_b64_tr_b16 v[62:63], v3 offset:55808
    ds_read_b64_tr_b16 v[130:131], v6 offset:5120
    v_mfma_f32_32x32x16_bf16 v[96:111], v[236:239], v[68:71], v[96:111]
    s_waitcnt lgkmcnt(6)
    v_mfma_f32_32x32x16_bf16 v[96:111], v[240:243], v[72:75], v[96:111]
    ds_read_b64_tr_b16 v[132:133], v7 offset:4096
    v_mfma_f32_32x32x16_bf16 v[96:111], v[244:247], v[76:79], v[96:111]
    s_waitcnt lgkmcnt(2)
    v_mfma_f32_32x32x16_bf16 v[96:111], v[248:251], v[56:59], v[96:111]
    ds_read_b64_tr_b16 v[134:135], v7 offset:5120
    v_mfma_f32_32x32x16_bf16 v[96:111], v[252:255], v[60:63], v[96:111]
    v_mfma_f32_32x32x16_bf16 v[96:111], v[40:43], v[44:47], v[96:111]
    s_waitcnt vmcnt(1)
    s_setprio 0
    s_barrier
    v_and_b32 v12, 0xffff0000, v34
    v_rcp_f32 v12, v12
    s_nop 0
    v_mul_f32 v12, 0xbeeff558, v12
    s_add_u32 s58, s58, 8192
    buffer_load_dwordx2 v[32:33], v11, s[40:43], s58 offen offset:0 sc1
    buffer_load_dwordx2 v[34:35], v11, s[40:43], s58 offen offset:256 sc1
    s_add_u32 m0, s52, 0
    s_add_u32 s56, s54, 43008
    buffer_load_dwordx4 v8, s[32:35], s56 offen  lds
    s_add_u32 m0, s52, 1024
    s_add_u32 s56, s54, 50176
    buffer_load_dwordx4 v8, s[32:35], s56 offen  lds
    v_mul_f32 v96, v96, v12
    v_mul_f32 v97, v97, v12
    v_mul_f32 v98, v98, v12
    v_fmaak_f32 v24, v96, v96, 0x409d30fc
    v_mul_f32 v99, v99, v12
    s_add_u32 m0, s52, 2048
    s_add_u32 s56, s54, 57344
    buffer_load_dwordx4 v8, s[32:35], s56 offen  lds
    v_fmaak_f32 v25, v97, v97, 0x409d30fc
    v_mul_f32 v100, v100, v12
    v_fmaak_f32 v26, v98, v98, 0x409d30fc
    v_mul_f32 v24, v24, v96
    v_mul_f32 v101, v101, v12
    v_fmaak_f32 v27, v99, v99, 0x409d30fc
    s_add_u32 m0, s52, 3072
    s_add_u32 s56, s54, 64512
    buffer_load_dwordx4 v8, s[32:35], s56 offen  lds
    v_mul_f32 v25, v25, v97
    v_mul_f32 v102, v102, v12
    v_fmaak_f32 v28, v100, v100, 0x409d30fc
    v_mul_f32 v26, v26, v98
    v_exp_f32 v24, v24
    s_waitcnt lgkmcnt(0)
    s_add_u32 m0, s52, 4096
    s_add_u32 s56, s54, 71680
    buffer_load_dwordx4 v8, s[32:35], s56 offen  lds
    v_mul_f32 v103, v103, v12
    v_fmaak_f32 v29, v101, v101, 0x409d30fc
    v_mul_f32 v27, v27, v99
    v_exp_f32 v25, v25
    v_fmaak_f32 v30, v102, v102, 0x409d30fc
    v_mul_f32 v28, v28, v100
    s_add_u32 m0, s52, 5120
    s_add_u32 s56, s54, 78848
    buffer_load_dwordx4 v8, s[32:35], s56 offen  lds
    v_exp_f32 v26, v26
    v_mul_f32 v96, v96, v104
    v_fmaak_f32 v31, v103, v103, 0x409d30fc
    v_mul_f32 v29, v29, v101
    v_exp_f32 v27, v27
    v_mul_f32 v97, v97, v105
    s_add_u32 m0, s53, 0
    s_add_u32 s56, s54, 114688
    buffer_load_dwordx4 v8, s[32:35], s56 offen  lds
    v_mul_f32 v30, v30, v102
    v_exp_f32 v28, v28
    v_mul_f32 v98, v98, v106
    v_add_f32 v24, 1.0, v24
    v_mul_f32 v31, v31, v103
    s_add_u32 m0, s53, 1024
    s_add_u32 s56, s54, 121856
    buffer_load_dwordx4 v8, s[32:35], s56 offen  lds
    v_exp_f32 v29, v29
    v_mul_f32 v99, v99, v107
    v_add_f32 v25, 1.0, v25
    v_exp_f32 v30, v30
    v_mul_f32 v100, v100, v108
    v_add_f32 v26, 1.0, v26
    s_add_u32 m0, s53, 2048
    s_add_u32 s56, s54, 129024
    buffer_load_dwordx4 v8, s[32:35], s56 offen  lds
    v_rcp_f32 v24, v24
    v_exp_f32 v31, v31
    v_mul_f32 v101, v101, v109
    v_add_f32 v27, 1.0, v27
    v_rcp_f32 v25, v25
    v_mul_f32 v102, v102, v110
    s_add_u32 m0, s53, 3072
    s_add_u32 s56, s54, 136192
    buffer_load_dwordx4 v8, s[32:35], s56 offen  lds
    v_add_f32 v28, 1.0, v28
    v_rcp_f32 v26, v26
    v_mul_f32 v103, v103, v111
    v_add_f32 v29, 1.0, v29
    v_rcp_f32 v27, v27
    s_add_u32 m0, s53, 4096
    s_add_u32 s56, s54, 143360
    buffer_load_dwordx4 v8, s[32:35], s56 offen  lds
    v_add_f32 v30, 1.0, v30
    v_rcp_f32 v28, v28
    v_mul_f32 v96, v96, v24
    v_add_f32 v31, 1.0, v31
    v_rcp_f32 v29, v29
    v_mul_f32 v97, v97, v25
    s_add_u32 m0, s53, 5120
    s_add_u32 s56, s54, 150528
    buffer_load_dwordx4 v8, s[32:35], s56 offen  lds
    v_rcp_f32 v30, v30
    v_mul_f32 v98, v98, v26
    v_rcp_f32 v31, v31
    v_mul_f32 v99, v99, v27
    v_mul_f32 v100, v100, v28
    v_mul_f32 v101, v101, v29
    v_mul_f32 v102, v102, v30
    v_mul_f32 v103, v103, v31
    v_cvt_pk_bf16_f32 v104, v96, v97
    v_cvt_pk_bf16_f32 v105, v98, v99
    v_cvt_pk_bf16_f32 v106, v100, v101
    v_cvt_pk_bf16_f32 v107, v102, v103
    s_add_u32 s56, s55, 114688
    buffer_store_dwordx4 v[104:107], v9, s[40:43], s56 offen sc1
    s_waitcnt vmcnt(13)
    v_cmp_ne_u32 vcc, s3, v33
    v_cmp_ne_u32 s[62:63], s3, v35
    s_or_b64 vcc, vcc, s[62:63]
    s_mov_b32 s57, 0
    s_cbranch_vccz gro_36
grp_35:
    buffer_load_dwordx2 v[32:33], v11, s[40:43], s58 offen offset:0 sc1
    buffer_load_dwordx2 v[34:35], v11, s[40:43], s58 offen offset:256 sc1
    s_add_u32 s57, s57, 1
    s_cmp_gt_u32 s57, 0x40000
    s_cbranch_scc1 gro_36
    s_waitcnt vmcnt(0)
    v_cmp_ne_u32 vcc, s3, v33
    v_cmp_ne_u32 s[62:63], s3, v35
    s_or_b64 vcc, vcc, s[62:63]
    s_cbranch_vccnz grp_35
gro_36:
    v_mov_b32 v44, v32
    v_mov_b32 v45, v32
    v_mov_b32 v46, v32
    ds_read_b64_tr_b16 v[64:65], v4 offset:0
    ds_read_b64_tr_b16 v[66:67], v4 offset:512
    ds_read_b64_tr_b16 v[68:69], v4 offset:2048
    ds_read_b64_tr_b16 v[70:71], v4 offset:2560
    ds_read_b64_tr_b16 v[72:73], v4 offset:4096
    ds_read_b64_tr_b16 v[74:75], v4 offset:4608
    ds_read_b64_tr_b16 v[76:77], v4 offset:6144
    ds_read_b64_tr_b16 v[78:79], v4 offset:6656
    ds_read_b64_tr_b16 v[56:57], v4 offset:8192
    ds_read_b64_tr_b16 v[58:59], v4 offset:8704
    s_barrier
    s_setprio 1
    s_waitcnt lgkmcnt(6)
    v_mfma_f32_32x32x16_bf16 v[80:95], v[144:147], v[64:67], 0
    ds_read_b64_tr_b16 v[60:61], v4 offset:10240
    ds_read_b64_tr_b16 v[62:63], v4 offset:10752
    v_mfma_f32_32x32x16_bf16 v[80:95], v[148:151], v[68:71], v[80:95]
    ds_read_b64_tr_b16 v[64:65], v4 offset:12288
    ds_read_b64_tr_b16 v[66:67], v4 offset:12800
    s_waitcnt lgkmcnt(6)
    v_mfma_f32_32x32x16_bf16 v[80:95], v[152:155], v[72:75], v[80:95]
    ds_read_b64_tr_b16 v[68:69], v4 offset:14336
    ds_read_b64_tr_b16 v[70:71], v4 offset:14848
    v_mfma_f32_32x32x16_bf16 v[80:95], v[156:159], v[76:79], v[80:95]
    ds_read_b64_tr_b16 v[72:73], v4 offset:16384
    ds_read_b64_tr_b16 v[74:75], v4 offset:16896
    s_waitcnt lgkmcnt(6)
    v_mfma_f32_32x32x16_bf16 v[80:95], v[160:163], v[56:59], v[80:95]
    ds_read_b64_tr_b16 v[76:77], v4 offset:18432
    ds_read_b64_tr_b16 v[78:79], v4 offset:18944
    v_mfma_f32_32x32x16_bf16 v[80:95], v[164:167], v[60:63], v[80:95]
    ds_read_b64_tr_b16 v[56:57], v4 offset:20480
    ds_read_b64_tr_b16 v[58:59], v4 offset:20992
    s_waitcnt lgkmcnt(6)
    v_mfma_f32_32x32x16_bf16 v[80:95], v[168:171], v[64:67], v[80:95]
    ds_read_b64_tr_b16 v[60:61], v4 offset:22528
    ds_read_b64_tr_b16 v[62:63], v4 offset:23040
    v_mfma_f32_32x32x16_bf16 v[80:95], v[172:175], v[68:71], v[80:95]
    ds_read_b64_tr_b16 v[64:65], v4 offset:24576
    ds_read_b64_tr_b16 v[66:67], v4 offset:25088
    s_waitcnt lgkmcnt(6)
    v_mfma_f32_32x32x16_bf16 v[80:95], v[176:179], v[72:75], v[80:95]
    ds_read_b64_tr_b16 v[68:69], v4 offset:26624
    ds_read_b64_tr_b16 v[70:71], v4 offset:27136
    s_waitcnt vmcnt(11)
    ds_read_b64_tr_b16 v[136:137], v6 offset:0
    v_mfma_f32_32x32x16_bf16 v[80:95], v[180:183], v[76:79], v[80:95]
    ds_read_b64_tr_b16 v[72:73], v4 offset:28672
    ds_read_b64_tr_b16 v[74:75], v4 offset:29184
    s_waitcnt lgkmcnt(7)
    v_mfma_f32_32x32x16_bf16 v[80:95], v[184:187], v[56:59], v[80:95]
    ds_read_b64_tr_b16 v[76:77], v4 offset:30720
    ds_read_b64_tr_b16 v[78:79], v4 offset:31232
    ds_read_b64_tr_b16 v[138:139], v6 offset:1024
    v_mfma_f32_32x32x16_bf16 v[80:95], v[188:191], v[60:63], v[80:95]
    ds_read_b64_tr_b16 v[56:57], v4 offset:32768
    ds_read_b64_tr_b16 v[58:59], v4 offset:33280
    s_waitcnt lgkmcnt(8)
    v_mfma_f32_32x32x16_bf16 v[80:95], v[192:195], v[64:67], v[80:95]
    ds_read_b64_tr_b16 v[60:61], v4 offset:34816
    ds_read_b64_tr_b16 v[62:63], v4 offset:35328
    ds_read_b64_tr_b16 v[140:141], v7 offset:0
    v_mfma_f32_32x32x16_bf16 v[80:95], v[196:199], v[68:71], v[80:95]
    ds_read_b64_tr_b16 v[64:65], v4 offset:36864
    ds_read_b64_tr_b16 v[66:67], v4 offset:37376
    s_waitcnt lgkmcnt(8)
    v_mfma_f32_32x32x16_bf16 v[80:95], v[200:203], v[72:75], v[80:95]
    ds_read_b64_tr_b16 v[68:69], v4 offset:38912
    ds_read_b64_tr_b16 v[70:71], v4 offset:39424
    ds_read_b64_tr_b16 v[142:143], v7 offset:1024
    v_mfma_f32_32x32x16_bf16 v[80:95], v[204:207], v[76:79], v[80:95]
    ds_read_b64_tr_b16 v[72:73], v4 offset:40960
    ds_read_b64_tr_b16 v[74:75], v4 offset:41472
    s_waitcnt lgkmcnt(8)
    v_mfma_f32_32x32x16_bf16 v[80:95], v[208:211], v[56:59], v[80:95]
    ds_read_b64_tr_b16 v[76:77], v4 offset:43008
    ds_read_b64_tr_b16 v[78:79], v4 offset:43520
    s_waitcnt vmcnt(9)
    ds_read_b64_tr_b16 v[48:49], v6 offset:2048
    v_mfma_f32_32x32x16_bf16 v[80:95], v[212:215], v[60:63], v[80:95]
    ds_read_b64_tr_b16 v[56:57], v4 offset:45056
    ds_read_b64_tr_b16 v[58:59], v4 offset:45568
    s_waitcnt lgkmcnt(8)
    v_mfma_f32_32x32x16_bf16 v[80:95], v[216:219], v[64:67], v[80:95]
    ds_read_b64_tr_b16 v[60:61], v4 offset:47104
    ds_read_b64_tr_b16 v[62:63], v4 offset:47616
    ds_read_b64_tr_b16 v[50:51], v6 offset:3072
    v_mfma_f32_32x32x16_bf16 v[80:95], v[220:223], v[68:71], v[80:95]
    ds_read_b64_tr_b16 v[64:65], v4 offset:49152
    ds_read_b64_tr_b16 v[66:67], v4 offset:49664
    s_waitcnt lgkmcnt(8)
    v_mfma_f32_32x32x16_bf16 v[80:95], v[224:227], v[72:75], v[80:95]
    ds_read_b64_tr_b16 v[68:69], v4 offset:51200
    ds_read_b64_tr_b16 v[70:71], v4 offset:51712
    ds_read_b64_tr_b16 v[52:53], v7 offset:2048
    v_mfma_f32_32x32x16_bf16 v[80:95], v[228:231], v[76:79], v[80:95]
    ds_read_b64_tr_b16 v[72:73], v4 offset:53248
    ds_read_b64_tr_b16 v[74:75], v4 offset:53760
    s_waitcnt lgkmcnt(8)
    v_mfma_f32_32x32x16_bf16 v[80:95], v[232:235], v[56:59], v[80:95]
    ds_read_b64_tr_b16 v[76:77], v4 offset:55296
    ds_read_b64_tr_b16 v[78:79], v4 offset:55808
    ds_read_b64_tr_b16 v[54:55], v7 offset:3072
    v_mfma_f32_32x32x16_bf16 v[80:95], v[236:239], v[60:63], v[80:95]
    ds_read_b64_tr_b16 v[56:57], v5 offset:0
    ds_read_b64_tr_b16 v[58:59], v5 offset:512
    s_waitcnt lgkmcnt(8)
    v_mfma_f32_32x32x16_bf16 v[80:95], v[240:243], v[64:67], v[80:95]
    ds_read_b64_tr_b16 v[60:61], v5 offset:2048
    ds_read_b64_tr_b16 v[62:63], v5 offset:2560
    ds_read_b64_tr_b16 v[38:39], v38
    v_mfma_f32_32x32x16_bf16 v[80:95], v[244:247], v[68:71], v[80:95]
    ds_read_b64_tr_b16 v[64:65], v5 offset:4096
    ds_read_b64_tr_b16 v[66:67], v5 offset:4608
    s_waitcnt lgkmcnt(8)
    v_mfma_f32_32x32x16_bf16 v[80:95], v[248:251], v[72:75], v[80:95]
    ds_read_b64_tr_b16 v[68:69], v5 offset:6144
    ds_read_b64_tr_b16 v[70:71], v5 offset:6656
    v_mfma_f32_32x32x16_bf16 v[80:95], v[252:255], v[76:79], v[80:95]
    ds_read_b64_tr_b16 v[72:73], v5 offset:8192
    ds_read_b64_tr_b16 v[74:75], v5 offset:8704
    v_mfma_f32_32x32x16_bf16 v[80:95], v[40:43], v[44:47], v[80:95]
    s_setprio 0
    s_barrier
    v_and_b32 v12, 0xffff0000, v32
    v_rcp_f32 v12, v12
    s_nop 0
    v_mul_f32 v12, 0xbeeff558, v12
    s_add_u32 m0, s52, 0
    s_add_u32 s56, s54, 86016
    buffer_load_dwordx4 v8, s[32:35], s56 offen  lds
    s_add_u32 m0, s52, 1024
    s_add_u32 s56, s54, 93184
    buffer_load_dwordx4 v8, s[32:35], s56 offen  lds
    s_waitcnt lgkmcnt(11)
    s_add_u32 m0, s52, 2048
    s_add_u32 s56, s54, 100352
    buffer_load_dwordx4 v8, s[32:35], s56 offen  lds
    v_mul_f32 v80, v80, v12
    v_mul_f32 v81, v81, v12
    v_mul_f32 v82, v82, v12
    v_fmaak_f32 v24, v80, v80, 0x409d30fc
    v_mul_f32 v83, v83, v12
    v_fmaak_f32 v25, v81, v81, 0x409d30fc
    v_mul_f32 v84, v84, v12
    v_fmaak_f32 v26, v82, v82, 0x409d30fc
    v_mul_f32 v24, v24, v80
    v_mul_f32 v85, v85, v12
    v_fmaak_f32 v27, v83, v83, 0x409d30fc
    s_add_u32 m0, s52, 3072
    s_add_u32 s56, s54, 107520
    buffer_load_dwordx4 v8, s[32:35], s56 offen  lds
    v_mul_f32 v25, v25, v81
    v_mul_f32 v86, v86, v12
    v_fmaak_f32 v28, v84, v84, 0x409d30fc
    v_mul_f32 v26, v26, v82
    v_exp_f32 v24, v24
    v_mul_f32 v87, v87, v12
    v_fmaak_f32 v29, v85, v85, 0x409d30fc
    v_mul_f32 v27, v27, v83
    v_exp_f32 v25, v25
    v_fmaak_f32 v30, v86, v86, 0x409d30fc
    v_mul_f32 v28, v28, v84
    v_exp_f32 v26, v26
    v_and_b32 v22, 3, v0
    v_lshlrev_b32 v22, 3, v22
    buffer_load_dword v23, v22, s[40:43], s77 offen sc1
    buffer_load_dword v22, v22, s[40:43], s76 offen sc1
    v_mul_f32 v80, v80, v88
    v_fmaak_f32 v31, v87, v87, 0x409d30fc
    v_mul_f32 v29, v29, v85
    v_exp_f32 v27, v27
    v_mul_f32 v81, v81, v89
    v_mul_f32 v30, v30, v86
    v_exp_f32 v28, v28
    v_mul_f32 v82, v82, v90
    v_add_f32 v24, 1.0, v24
    v_mul_f32 v31, v31, v87
    v_exp_f32 v29, v29
    v_mul_f32 v83, v83, v91
    v_add_f32 v25, 1.0, v25
    v_exp_f32 v30, v30
    v_mul_f32 v84, v84, v92
    v_add_f32 v26, 1.0, v26
    v_rcp_f32 v24, v24
    v_exp_f32 v31, v31
    v_mul_f32 v85, v85, v93
    v_add_f32 v27, 1.0, v27
    v_rcp_f32 v25, v25
    v_mul_f32 v86, v86, v94
    v_add_f32 v28, 1.0, v28
    v_rcp_f32 v26, v26
    v_mul_f32 v87, v87, v95
    v_add_f32 v29, 1.0, v29
    v_rcp_f32 v27, v27
    v_add_f32 v30, 1.0, v30
    v_rcp_f32 v28, v28
    v_mul_f32 v80, v80, v24
    v_add_f32 v31, 1.0, v31
    v_rcp_f32 v29, v29
    v_mul_f32 v81, v81, v25
    v_rcp_f32 v30, v30
    v_mul_f32 v82, v82, v26
    v_rcp_f32 v31, v31
    v_mul_f32 v83, v83, v27
    v_mul_f32 v84, v84, v28
    v_mul_f32 v85, v85, v29
    v_mul_f32 v86, v86, v30
    v_mul_f32 v87, v87, v31
    v_cvt_pk_bf16_f32 v88, v80, v81
    v_cvt_pk_bf16_f32 v89, v82, v83
    v_cvt_pk_bf16_f32 v90, v84, v85
    v_cvt_pk_bf16_f32 v91, v86, v87
    s_add_u32 s56, s55, 229376
    buffer_store_dwordx4 v[88:91], v9, s[40:43], s56 offen sc1
    v_mov_b32 v44, v34
    v_mov_b32 v45, v34
    v_mov_b32 v46, v34
    s_waitcnt vmcnt(7)
    s_barrier
    s_setprio 1
    s_waitcnt lgkmcnt(7)
    v_mfma_f32_32x32x16_bf16 v[96:111], v[144:147], v[56:59], 0
    ds_read_b64_tr_b16 v[76:77], v5 offset:10240
    ds_read_b64_tr_b16 v[78:79], v5 offset:10752
    v_mfma_f32_32x32x16_bf16 v[96:111], v[148:151], v[60:63], v[96:111]
    ds_read_b64_tr_b16 v[56:57], v5 offset:12288
    ds_read_b64_tr_b16 v[58:59], v5 offset:12800
    s_waitcnt lgkmcnt(6)
    v_mfma_f32_32x32x16_bf16 v[96:111], v[152:155], v[64:67], v[96:111]
    ds_read_b64_tr_b16 v[60:61], v5 offset:14336
    ds_read_b64_tr_b16 v[62:63], v5 offset:14848
    v_mfma_f32_32x32x16_bf16 v[96:111], v[156:159], v[68:71], v[96:111]
    ds_read_b64_tr_b16 v[64:65], v5 offset:16384
    ds_read_b64_tr_b16 v[66:67], v5 offset:16896
    ds_read_b64_tr_b16 v[144:145], v6 offset:4096
    s_waitcnt lgkmcnt(7)
    v_mfma_f32_32x32x16_bf16 v[96:111], v[160:163], v[72:75], v[96:111]
    ds_read_b64_tr_b16 v[68:69], v5 offset:18432
    ds_read_b64_tr_b16 v[70:71], v5 offset:18944
    ds_read_b64_tr_b16 v[146:147], v6 offset:5120
    v_mfma_f32_32x32x16_bf16 v[96:111], v[164:167], v[76:79], v[96:111]
    ds_read_b64_tr_b16 v[72:73], v5 offset:20480
    ds_read_b64_tr_b16 v[74:75], v5 offset:20992
    ds_read_b64_tr_b16 v[148:149], v7 offset:4096
    s_waitcnt lgkmcnt(9)
    v_mfma_f32_32x32x16_bf16 v[96:111], v[168:171], v[56:59], v[96:111]
    ds_read_b64_tr_b16 v[76:77], v5 offset:22528
    ds_read_b64_tr_b16 v[78:79], v5 offset:23040
    ds_read_b64_tr_b16 v[150:151], v7 offset:5120
    v_mfma_f32_32x32x16_bf16 v[96:111], v[172:175], v[60:63], v[96:111]
    ds_read_b64_tr_b16 v[56:57], v5 offset:24576
    ds_read_b64_tr_b16 v[58:59], v5 offset:25088
    s_waitcnt vmcnt(5)
    ds_read_b64_tr_b16 v[152:153], v6 offset:0
    s_waitcnt lgkmcnt(10)
    v_mfma_f32_32x32x16_bf16 v[96:111], v[176:179], v[64:67], v[96:111]
    ds_read_b64_tr_b16 v[60:61], v5 offset:26624
    ds_read_b64_tr_b16 v[62:63], v5 offset:27136
    ds_read_b64_tr_b16 v[154:155], v6 offset:1024
    v_mfma_f32_32x32x16_bf16 v[96:111], v[180:183], v[68:71], v[96:111]
    ds_read_b64_tr_b16 v[64:65], v5 offset:28672
    ds_read_b64_tr_b16 v[66:67], v5 offset:29184
    ds_read_b64_tr_b16 v[156:157], v7 offset:0
    s_waitcnt lgkmcnt(10)
    v_mfma_f32_32x32x16_bf16 v[96:111], v[184:187], v[72:75], v[96:111]
    ds_read_b64_tr_b16 v[68:69], v5 offset:30720
    ds_read_b64_tr_b16 v[70:71], v5 offset:31232
    ds_read_b64_tr_b16 v[158:159], v7 offset:1024
    v_mfma_f32_32x32x16_bf16 v[96:111], v[188:191], v[76:79], v[96:111]
    ds_read_b64_tr_b16 v[72:73], v5 offset:32768
    ds_read_b64_tr_b16 v[74:75], v5 offset:33280
    s_waitcnt vmcnt(3)
    ds_read_b64_tr_b16 v[160:161], v6 offset:2048
    s_waitcnt lgkmcnt(10)
    v_mfma_f32_32x32x16_bf16 v[96:111], v[192:195], v[56:59], v[96:111]
    ds_read_b64_tr_b16 v[76:77], v5 offset:34816
    ds_read_b64_tr_b16 v[78:79], v5 offset:35328
    ds_read_b64_tr_b16 v[162:163], v6 offset:3072
    v_mfma_f32_32x32x16_bf16 v[96:111], v[196:199], v[60:63], v[96:111]
    ds_read_b64_tr_b16 v[56:57], v5 offset:36864
    ds_read_b64_tr_b16 v[58:59], v5 offset:37376
    ds_read_b64_tr_b16 v[164:165], v7 offset:2048
    s_waitcnt lgkmcnt(10)
    v_mfma_f32_32x32x16_bf16 v[96:111], v[200:203], v[64:67], v[96:111]
    ds_read_b64_tr_b16 v[60:61], v5 offset:38912
    ds_read_b64_tr_b16 v[62:63], v5 offset:39424
    ds_read_b64_tr_b16 v[166:167], v7 offset:3072
    v_mfma_f32_32x32x16_bf16 v[96:111], v[204:207], v[68:71], v[96:111]
    ds_read_b64_tr_b16 v[64:65], v5 offset:40960
    ds_read_b64_tr_b16 v[66:67], v5 offset:41472
    v_subrev_u32 v6, s59, v6
    v_subrev_u32 v7, s59, v7
    ds_read_b64_tr_b16 v[168:169], v6 offset:0
    s_waitcnt lgkmcnt(10)
    v_mfma_f32_32x32x16_bf16 v[96:111], v[208:211], v[72:75], v[96:111]
    ds_read_b64_tr_b16 v[68:69], v5 offset:43008
    ds_read_b64_tr_b16 v[70:71], v5 offset:43520
    ds_read_b64_tr_b16 v[170:171], v6 offset:1024
    v_mfma_f32_32x32x16_bf16 v[96:111], v[212:215], v[76:79], v[96:111]
    ds_read_b64_tr_b16 v[72:73], v5 offset:45056
    ds_read_b64_tr_b16 v[74:75], v5 offset:45568
    ds_read_b64_tr_b16 v[172:173], v7 offset:0
    s_waitcnt lgkmcnt(10)
    v_mfma_f32_32x32x16_bf16 v[96:111], v[216:219], v[56:59], v[96:111]
    ds_read_b64_tr_b16 v[76:77], v5 offset:47104
    ds_read_b64_tr_b16 v[78:79], v5 offset:47616
    ds_read_b64_tr_b16 v[174:175], v7 offset:1024
    v_mfma_f32_32x32x16_bf16 v[96:111], v[220:223], v[60:63], v[96:111]
    ds_read_b64_tr_b16 v[56:57], v5 offset:49152
    ds_read_b64_tr_b16 v[58:59], v5 offset:49664
    ds_read_b64_tr_b16 v[176:177], v6 offset:2048
    s_waitcnt lgkmcnt(10)
    v_mfma_f32_32x32x16_bf16 v[96:111], v[224:227], v[64:67], v[96:111]
    ds_read_b64_tr_b16 v[60:61], v5 offset:51200
    ds_read_b64_tr_b16 v[62:63], v5 offset:51712
    ds_read_b64_tr_b16 v[178:179], v6 offset:3072
    v_mfma_f32_32x32x16_bf16 v[96:111], v[228:231], v[68:71], v[96:111]
    ds_read_b64_tr_b16 v[64:65], v5 offset:53248
    ds_read_b64_tr_b16 v[66:67], v5 offset:53760
    ds_read_b64_tr_b16 v[180:181], v7 offset:2048
    s_waitcnt lgkmcnt(10)
    v_mfma_f32_32x32x16_bf16 v[96:111], v[232:235], v[72:75], v[96:111]
    ds_read_b64_tr_b16 v[68:69], v5 offset:55296
    ds_read_b64_tr_b16 v[70:71], v5 offset:55808
    ds_read_b64_tr_b16 v[182:183], v7 offset:3072
    v_mfma_f32_32x32x16_bf16 v[96:111], v[236:239], v[76:79], v[96:111]
    ds_read_b64_tr_b16 v[184:185], v6 offset:4096
    s_waitcnt lgkmcnt(8)
    v_mfma_f32_32x32x16_bf16 v[96:111], v[240:243], v[56:59], v[96:111]
    ds_read_b64_tr_b16 v[186:187], v6 offset:5120
    v_mfma_f32_32x32x16_bf16 v[96:111], v[244:247], v[60:63], v[96:111]
    ds_read_b64_tr_b16 v[188:189], v7 offset:4096
    s_waitcnt lgkmcnt(4)
    v_mfma_f32_32x32x16_bf16 v[96:111], v[248:251], v[64:67], v[96:111]
    ds_read_b64_tr_b16 v[190:191], v7 offset:5120
    v_mfma_f32_32x32x16_bf16 v[96:111], v[252:255], v[68:71], v[96:111]
    v_mfma_f32_32x32x16_bf16 v[96:111], v[40:43], v[44:47], v[96:111]
    s_setprio 0
    s_barrier
    v_and_b32 v12, 0xffff0000, v34
    v_rcp_f32 v12, v12
    s_nop 0
    v_mul_f32 v12, 0xbeeff558, v12
    buffer_load_dword v21, v20, s[40:43], s74 offen sc1
    s_add_u32 m0, s53, 0
    s_add_u32 s56, s54, 157696
    buffer_load_dwordx4 v8, s[32:35], s56 offen  lds
    s_add_u32 m0, s53, 1024
    s_add_u32 s56, s54, 164864
    buffer_load_dwordx4 v8, s[32:35], s56 offen  lds
    v_mul_f32 v96, v96, v12
    v_mul_f32 v97, v97, v12
    v_mul_f32 v98, v98, v12
    v_fmaak_f32 v24, v96, v96, 0x409d30fc
    v_mul_f32 v99, v99, v12
    s_waitcnt lgkmcnt(4)
    s_add_u32 m0, s53, 2048
    s_add_u32 s56, s54, 172032
    buffer_load_dwordx4 v8, s[32:35], s56 offen  lds
    v_fmaak_f32 v25, v97, v97, 0x409d30fc
    v_mul_f32 v100, v100, v12
    v_fmaak_f32 v26, v98, v98, 0x409d30fc
    v_mul_f32 v24, v24, v96
    v_mul_f32 v101, v101, v12
    v_fmaak_f32 v27, v99, v99, 0x409d30fc
    s_add_u32 m0, s53, 3072
    s_add_u32 s56, s54, 179200
    buffer_load_dwordx4 v8, s[32:35], s56 offen  lds
    v_mul_f32 v25, v25, v97
    v_mul_f32 v102, v102, v12
    v_fmaak_f32 v28, v100, v100, 0x409d30fc
    v_mul_f32 v26, v26, v98
    v_exp_f32 v24, v24
    s_waitcnt lgkmcnt(0)
    s_add_u32 m0, s53, 4096
    s_add_u32 s56, s54, 186368
    buffer_load_dwordx4 v8, s[32:35], s56 offen  lds
    v_mul_f32 v103, v103, v12
    v_fmaak_f32 v29, v101, v101, 0x409d30fc
    v_mul_f32 v27, v27, v99
    v_exp_f32 v25, v25
    v_fmaak_f32 v30, v102, v102, 0x409d30fc
    v_mul_f32 v28, v28, v100
    s_add_u32 m0, s53, 5120
    s_add_u32 s56, s54, 193536
    buffer_load_dwordx4 v8, s[32:35], s56 offen  lds
    v_exp_f32 v26, v26
    v_mul_f32 v96, v96, v104
    v_fmaak_f32 v31, v103, v103, 0x409d30fc
    v_mul_f32 v29, v29, v101
    v_exp_f32 v27, v27
    v_mul_f32 v97, v97, v105
    v_mul_f32 v30, v30, v102
    v_exp_f32 v28, v28
    v_mul_f32 v98, v98, v106
    v_add_f32 v24, 1.0, v24
    v_mul_f32 v31, v31, v103
    v_exp_f32 v29, v29
    v_mul_f32 v99, v99, v107
    v_add_f32 v25, 1.0, v25
    v_exp_f32 v30, v30
    v_mul_f32 v100, v100, v108
    v_add_f32 v26, 1.0, v26
    v_rcp_f32 v24, v24
    v_exp_f32 v31, v31
    v_mul_f32 v101, v101, v109
    v_add_f32 v27, 1.0, v27
    v_rcp_f32 v25, v25
    v_mul_f32 v102, v102, v110
    v_add_f32 v28, 1.0, v28
    v_rcp_f32 v26, v26
    v_mul_f32 v103, v103, v111
    v_add_f32 v29, 1.0, v29
    v_rcp_f32 v27, v27
    v_add_f32 v30, 1.0, v30
    v_rcp_f32 v28, v28
    v_mul_f32 v96, v96, v24
    v_add_f32 v31, 1.0, v31
    v_rcp_f32 v29, v29
    v_mul_f32 v97, v97, v25
    v_rcp_f32 v30, v30
    v_mul_f32 v98, v98, v26
    v_rcp_f32 v31, v31
    v_mul_f32 v99, v99, v27
    v_mul_f32 v100, v100, v28
    v_mul_f32 v101, v101, v29
    v_mul_f32 v102, v102, v30
    v_mul_f32 v103, v103, v31
    v_cvt_pk_bf16_f32 v104, v96, v97
    v_cvt_pk_bf16_f32 v105, v98, v99
    v_cvt_pk_bf16_f32 v106, v100, v101
    v_cvt_pk_bf16_f32 v107, v102, v103
    s_add_u32 s56, s55, 344064
    buffer_store_dwordx4 v[104:107], v9, s[40:43], s56 offen sc1
    s_setprio 0
    s_waitcnt vmcnt(7)
    s_mov_b32 s57, 0
poll_37:
    v_cmp_ne_u32 s[64:65], s3, v21
    s_cmp_eq_u64 s[64:65], 0
    s_cbranch_scc1 pd_38
    s_add_u32 s57, s57, 1
    s_cmp_gt_u32 s57, 0x40000
    s_cbranch_scc1 pd_38
    s_mov_b64 exec, s[64:65]
    s_cbranch_execz ps_39
    buffer_load_dword v21, v20, s[40:43], s74 offen sc1
ps_39:
    s_mov_b64 exec, -1
    s_waitcnt vmcnt(0)
    s_branch poll_37
pd_38:
    s_add_u32 s58, s73, 0
    buffer_load_dwordx4 v[56:59], v9, s[40:43], s58 offen offset:0 sc1
    buffer_load_dwordx4 v[60:63], v9, s[40:43], s58 offen offset:1024 sc1
    buffer_load_dwordx4 v[64:67], v9, s[40:43], s58 offen offset:2048 sc1
    v_mov_b32 v2, v36
    v_mov_b32 v3, v37
    v_mov_b32 v4, v38
    v_mov_b32 v5, v39
    v_and_b32 v22, 0xffff0000, v22
    v_mul_f32 v22, 0xbeeff558, v22
    v_rcp_f32 v22, v22
    v_and_b32 v23, 0xffff0000, v23
    v_mul_f32 v23, 0xbeeff558, v23
    v_rcp_f32 v23, v23
    s_add_u32 s60, s60, 65536
    s_add_u32 s74, s74, 65536
    s_mov_b32 s79, 4294918144
    s_cmp_ge_u32 s48, 6
    s_cselect_b32 s79, 16384, s79
    s_waitcnt vmcnt(8)
    ds_read_b64_tr_b16 v[192:193], v6 offset:0
    ds_read_b64_tr_b16 v[194:195], v6 offset:1024
    ds_read_b64_tr_b16 v[196:197], v7 offset:0
    ds_read_b64_tr_b16 v[198:199], v7 offset:1024
    s_waitcnt vmcnt(6)
    ds_read_b64_tr_b16 v[200:201], v6 offset:2048
    ds_read_b64_tr_b16 v[202:203], v6 offset:3072
    ds_read_b64_tr_b16 v[204:205], v7 offset:2048
    ds_read_b64_tr_b16 v[206:207], v7 offset:3072
    s_waitcnt vmcnt(4)
    ds_read_b64_tr_b16 v[208:209], v6 offset:4096
    ds_read_b64_tr_b16 v[210:211], v6 offset:5120
    ds_read_b64_tr_b16 v[212:213], v7 offset:4096
    ds_read_b64_tr_b16 v[214:215], v7 offset:5120
    s_waitcnt vmcnt(3)
    s_barrier
    buffer_load_dwordx4 v[68:71], v9, s[40:43], s58 offen offset:3072 sc1
    s_add_u32 s58, s73, 4096
    buffer_load_dwordx4 v[72:75], v9, s[40:43], s58 offen offset:0 sc1
    buffer_load_dwordx4 v[76:79], v9, s[40:43], s58 offen offset:1024 sc1
    buffer_load_dwordx4 v[216:219], v9, s[40:43], s58 offen offset:2048 sc1
    buffer_load_dwordx4 v[220:223], v9, s[40:43], s58 offen offset:3072 sc1
    s_add_u32 s58, s73, 8192
    buffer_load_dwordx4 v[24:27], v9, s[40:43], s58 offen offset:0 sc1
    s_waitcnt vmcnt(8)
    v_mfma_f32_32x32x16_bf16 v[80:95], v[112:115], v[56:59], 0
    v_mfma_f32_32x32x16_bf16 v[96:111], v[116:119], v[56:59], 0
    buffer_load_dwordx4 v[28:31], v9, s[40:43], s58 offen offset:1024 sc1
    s_waitcnt vmcnt(8)
    v_mfma_f32_32x32x16_bf16 v[80:95], v[120:123], v[60:63], v[80:95]
    v_mfma_f32_32x32x16_bf16 v[96:111], v[124:127], v[60:63], v[96:111]
    buffer_load_dwordx4 v[32:35], v9, s[40:43], s58 offen offset:2048 sc1
    s_waitcnt vmcnt(8)
    v_mfma_f32_32x32x16_bf16 v[80:95], v[128:131], v[64:67], v[80:95]
    v_mfma_f32_32x32x16_bf16 v[96:111], v[132:135], v[64:67], v[96:111]
    buffer_load_dwordx4 v[36:39], v9, s[40:43], s58 offen offset:3072 sc1
    s_waitcnt vmcnt(8)
    v_mfma_f32_32x32x16_bf16 v[80:95], v[136:139], v[68:71], v[80:95]
    v_mfma_f32_32x32x16_bf16 v[96:111], v[140:143], v[68:71], v[96:111]
    s_add_u32 s58, s73, 12288
    buffer_load_dwordx4 v[40:43], v9, s[40:43], s58 offen offset:0 sc1
    s_waitcnt vmcnt(8)
    v_mfma_f32_32x32x16_bf16 v[80:95], v[48:51], v[72:75], v[80:95]
    v_mfma_f32_32x32x16_bf16 v[96:111], v[52:55], v[72:75], v[96:111]
    buffer_load_dwordx4 v[44:47], v9, s[40:43], s58 offen offset:1024 sc1
    s_waitcnt vmcnt(8)
    v_mfma_f32_32x32x16_bf16 v[80:95], v[144:147], v[76:79], v[80:95]
    v_mfma_f32_32x32x16_bf16 v[96:111], v[148:151], v[76:79], v[96:111]
    s_waitcnt vmcnt(7)
    v_mfma_f32_32x32x16_bf16 v[80:95], v[152:155], v[216:219], v[80:95]
    v_mfma_f32_32x32x16_bf16 v[96:111], v[156:159], v[216:219], v[96:111]
    buffer_load_dword v21, v20, s[40:43], s74 offen sc1
    s_waitcnt vmcnt(7)
    v_mfma_f32_32x32x16_bf16 v[80:95], v[160:163], v[220:223], v[80:95]
    v_mfma_f32_32x32x16_bf16 v[96:111], v[164:167], v[220:223], v[96:111]
    s_waitcnt vmcnt(6)
    v_mfma_f32_32x32x16_bf16 v[80:95], v[168:171], v[24:27], v[80:95]
    v_mfma_f32_32x32x16_bf16 v[96:111], v[172:175], v[24:27], v[96:111]
    s_waitcnt vmcnt(5)
    v_mfma_f32_32x32x16_bf16 v[80:95], v[176:179], v[28:31], v[80:95]
    v_mfma_f32_32x32x16_bf16 v[96:111], v[180:183], v[28:31], v[96:111]
    s_waitcnt vmcnt(0)
    s_mov_b32 s57, 0
poll_40:
    v_cmp_ne_u32 s[64:65], s3, v21
    s_cmp_eq_u64 s[64:65], 0
    s_cbranch_scc1 pd_41
    s_add_u32 s57, s57, 1
    s_cmp_gt_u32 s57, 0x40000
    s_cbranch_scc1 pd_41
    s_mov_b64 exec, s[64:65]
    s_cbranch_execz ps_42
    buffer_load_dword v21, v20, s[40:43], s74 offen sc1
ps_42:
    s_mov_b64 exec, -1
    s_waitcnt vmcnt(0)
    s_branch poll_40
pd_41:
    s_add_u32 s58, s73, 229376
    buffer_load_dwordx4 v[56:59], v9, s[40:43], s58 offen offset:0 sc1
    buffer_load_dwordx4 v[60:63], v9, s[40:43], s58 offen offset:1024 sc1
    buffer_load_dwordx4 v[64:67], v9, s[40:43], s58 offen offset:2048 sc1
    v_mfma_f32_32x32x16_bf16 v[80:95], v[184:187], v[32:35], v[80:95]
    v_mfma_f32_32x32x16_bf16 v[96:111], v[188:191], v[32:35], v[96:111]
    buffer_load_dwordx4 v[68:71], v9, s[40:43], s58 offen offset:3072 sc1
    s_add_u32 s58, s73, 233472
    buffer_load_dwordx4 v[72:75], v9, s[40:43], s58 offen offset:0 sc1
    buffer_load_dwordx4 v[76:79], v9, s[40:43], s58 offen offset:1024 sc1
    s_waitcnt lgkmcnt(8)
    v_mfma_f32_32x32x16_bf16 v[80:95], v[192:195], v[36:39], v[80:95]
    v_mfma_f32_32x32x16_bf16 v[96:111], v[196:199], v[36:39], v[96:111]
    buffer_load_dwordx4 v[216:219], v9, s[40:43], s58 offen offset:2048 sc1
    buffer_load_dwordx4 v[220:223], v9, s[40:43], s58 offen offset:3072 sc1
    s_add_u32 s58, s73, 237568
    buffer_load_dwordx4 v[24:27], v9, s[40:43], s58 offen offset:0 sc1
    s_waitcnt lgkmcnt(4)
    v_mfma_f32_32x32x16_bf16 v[80:95], v[200:203], v[40:43], v[80:95]
    v_mfma_f32_32x32x16_bf16 v[96:111], v[204:207], v[40:43], v[96:111]
    buffer_load_dwordx4 v[28:31], v9, s[40:43], s58 offen offset:1024 sc1
    buffer_load_dwordx4 v[32:35], v9, s[40:43], s58 offen offset:2048 sc1
    buffer_load_dwordx4 v[36:39], v9, s[40:43], s58 offen offset:3072 sc1
    s_waitcnt lgkmcnt(0)
    v_mfma_f32_32x32x16_bf16 v[80:95], v[208:211], v[44:47], v[80:95]
    v_mfma_f32_32x32x16_bf16 v[96:111], v[212:215], v[44:47], v[96:111]
    s_add_u32 s58, s73, 241664
    buffer_load_dwordx4 v[40:43], v9, s[40:43], s58 offen offset:0 sc1
    buffer_load_dwordx4 v[44:47], v9, s[40:43], s58 offen offset:1024 sc1
    s_waitcnt vmcnt(13)
    v_mfma_f32_32x32x16_bf16 v[224:239], v[112:115], v[56:59], 0
    v_mfma_f32_32x32x16_bf16 v[240:255], v[116:119], v[56:59], 0
    s_waitcnt vmcnt(12)
    v_mfma_f32_32x32x16_bf16 v[224:239], v[120:123], v[60:63], v[224:239]
    v_mfma_f32_32x32x16_bf16 v[240:255], v[124:127], v[60:63], v[240:255]
    s_waitcnt vmcnt(11)
    v_mfma_f32_32x32x16_bf16 v[224:239], v[128:131], v[64:67], v[224:239]
    v_mfma_f32_32x32x16_bf16 v[240:255], v[132:135], v[64:67], v[240:255]
    s_waitcnt vmcnt(10)
    v_mfma_f32_32x32x16_bf16 v[224:239], v[136:139], v[68:71], v[224:239]
    ds_write_b128 v13, v[80:83] offset:0
    v_mfma_f32_32x32x16_bf16 v[240:255], v[140:143], v[68:71], v[240:255]
    ds_write_b128 v14, v[84:87] offset:1024
    s_waitcnt vmcnt(9)
    v_mfma_f32_32x32x16_bf16 v[224:239], v[48:51], v[72:75], v[224:239]
    ds_write_b128 v15, v[88:91] offset:2048
    v_mfma_f32_32x32x16_bf16 v[240:255], v[52:55], v[72:75], v[240:255]
    ds_write_b128 v16, v[92:95] offset:3072
    s_waitcnt vmcnt(8)
    v_mfma_f32_32x32x16_bf16 v[224:239], v[144:147], v[76:79], v[224:239]
    ds_write_b128 v13, v[96:99] offset:4096
    v_mfma_f32_32x32x16_bf16 v[240:255], v[148:151], v[76:79], v[240:255]
    ds_write_b128 v14, v[100:103] offset:5120
    s_waitcnt vmcnt(7)
    v_mfma_f32_32x32x16_bf16 v[224:239], v[152:155], v[216:219], v[224:239]
    ds_write_b128 v15, v[104:107] offset:6144
    v_mfma_f32_32x32x16_bf16 v[240:255], v[156:159], v[216:219], v[240:255]
    ds_write_b128 v16, v[108:111] offset:7168
    s_waitcnt vmcnt(6)
    v_mfma_f32_32x32x16_bf16 v[224:239], v[160:163], v[220:223], v[224:239]
    v_add_u32 v13, s79, v13
    v_add_u32 v14, s79, v14
    v_add_u32 v15, s79, v15
    v_add_u32 v16, s79, v16
    v_mfma_f32_32x32x16_bf16 v[240:255], v[164:167], v[220:223], v[240:255]
    s_waitcnt lgkmcnt(0)
    s_barrier
    ds_read_b128 v[80:83], v18 offset:0
    ds_read_b128 v[84:87], v18 offset:8192
    ds_read_b128 v[88:91], v18 offset:16384
    ds_read_b128 v[92:95], v18 offset:24576
    s_waitcnt vmcnt(5)
    v_mfma_f32_32x32x16_bf16 v[224:239], v[168:171], v[24:27], v[224:239]
    ds_read_b128 v[96:99], v18 offset:32768
    ds_read_b128 v[100:103], v18 offset:40960
    ds_read_b128 v[104:107], v18 offset:49152
    ds_read_b128 v[108:111], v18 offset:57344
    v_mfma_f32_32x32x16_bf16 v[240:255], v[172:175], v[24:27], v[240:255]
    s_waitcnt vmcnt(4)
    v_mfma_f32_32x32x16_bf16 v[224:239], v[176:179], v[28:31], v[224:239]
    s_waitcnt lgkmcnt(6)
    v_add_f32 v80, v80, v84
    v_add_f32 v81, v81, v85
    v_add_f32 v82, v82, v86
    v_add_f32 v83, v83, v87
    s_waitcnt lgkmcnt(5)
    v_add_f32 v80, v80, v88
    v_add_f32 v81, v81, v89
    v_add_f32 v82, v82, v90
    v_add_f32 v83, v83, v91
    v_mfma_f32_32x32x16_bf16 v[240:255], v[180:183], v[28:31], v[240:255]
    v_lshlrev_b32 v88, 16, v2
    v_and_b32 v89, 0xffff0000, v2
    v_lshlrev_b32 v90, 16, v3
    v_and_b32 v91, 0xffff0000, v3
    s_waitcnt lgkmcnt(4)
    v_add_f32 v80, v80, v92
    v_add_f32 v81, v81, v93
    v_add_f32 v82, v82, v94
    v_add_f32 v83, v83, v95
    s_waitcnt vmcnt(3)
    v_mfma_f32_32x32x16_bf16 v[224:239], v[184:187], v[32:35], v[224:239]
    s_waitcnt lgkmcnt(3)
    v_add_f32 v80, v80, v96
    v_add_f32 v81, v81, v97
    v_add_f32 v82, v82, v98
    v_add_f32 v83, v83, v99
    v_mfma_f32_32x32x16_bf16 v[240:255], v[188:191], v[32:35], v[240:255]
    s_waitcnt lgkmcnt(2)
    v_add_f32 v80, v80, v100
    v_add_f32 v81, v81, v101
    v_add_f32 v82, v82, v102
    v_add_f32 v83, v83, v103
    s_waitcnt lgkmcnt(1)
    v_add_f32 v80, v80, v104
    v_add_f32 v81, v81, v105
    v_add_f32 v82, v82, v106
    v_add_f32 v83, v83, v107
    s_waitcnt vmcnt(2)
    v_mfma_f32_32x32x16_bf16 v[224:239], v[192:195], v[36:39], v[224:239]
    s_waitcnt lgkmcnt(0)
    v_add_f32 v80, v80, v108
    v_add_f32 v81, v81, v109
    v_add_f32 v82, v82, v110
    v_add_f32 v83, v83, v111
    v_mfma_f32_32x32x16_bf16 v[240:255], v[196:199], v[36:39], v[240:255]
    v_mul_f32 v80, v80, v22
    v_mul_f32 v81, v81, v22
    v_mul_f32 v82, v82, v22
    v_mul_f32 v83, v83, v22
    v_cvt_pk_bf16_f32 v84, v80, v81
    v_cvt_pk_bf16_f32 v85, v82, v83
    s_waitcnt vmcnt(1)
    v_mfma_f32_32x32x16_bf16 v[224:239], v[200:203], v[40:43], v[224:239]
    v_lshlrev_b32 v80, 16, v84
    v_and_b32 v81, 0xffff0000, v84
    v_lshlrev_b32 v82, 16, v85
    v_and_b32 v83, 0xffff0000, v85
    v_mfma_f32_32x32x16_bf16 v[240:255], v[204:207], v[40:43], v[240:255]
    v_add_f32 v80, v80, v88
    v_add_f32 v81, v81, v89
    v_add_f32 v82, v82, v90
    v_add_f32 v83, v83, v91
    v_cvt_pk_bf16_f32 v86, v80, v81
    v_cvt_pk_bf16_f32 v87, v82, v83
    s_waitcnt vmcnt(0)
    v_mfma_f32_32x32x16_bf16 v[224:239], v[208:211], v[44:47], v[224:239]
    buffer_store_dwordx2 v[86:87], v19, s[36:39], s61 offen sc1
    v_mfma_f32_32x32x16_bf16 v[240:255], v[212:215], v[44:47], v[240:255]
    v_add_u32 v18, 114688, v17
    s_nop 7
    s_nop 1
    ds_write_b128 v13, v[224:227] offset:0
    ds_write_b128 v14, v[228:231] offset:1024
    ds_write_b128 v15, v[232:235] offset:2048
    ds_write_b128 v16, v[236:239] offset:3072
    ds_write_b128 v13, v[240:243] offset:4096
    ds_write_b128 v14, v[244:247] offset:5120
    ds_write_b128 v15, v[248:251] offset:6144
    ds_write_b128 v16, v[252:255] offset:7168
    s_waitcnt lgkmcnt(0)
    s_barrier
    ds_read_b128 v[224:227], v17 offset:0
    ds_read_b128 v[228:231], v17 offset:8192
    ds_read_b128 v[232:235], v17 offset:16384
    ds_read_b128 v[236:239], v17 offset:24576
    ds_read_b128 v[240:243], v17 offset:32768
    ds_read_b128 v[244:247], v17 offset:40960
    ds_read_b128 v[248:251], v18 offset:0
    ds_read_b128 v[252:255], v18 offset:8192
    s_waitcnt lgkmcnt(6)
    v_add_f32 v224, v224, v228
    v_add_f32 v225, v225, v229
    v_add_f32 v226, v226, v230
    v_add_f32 v227, v227, v231
    s_waitcnt lgkmcnt(5)
    v_add_f32 v224, v224, v232
    v_add_f32 v225, v225, v233
    v_add_f32 v226, v226, v234
    v_add_f32 v227, v227, v235
    v_lshlrev_b32 v232, 16, v4
    v_and_b32 v233, 0xffff0000, v4
    v_lshlrev_b32 v234, 16, v5
    v_and_b32 v235, 0xffff0000, v5
    s_waitcnt lgkmcnt(4)
    v_add_f32 v224, v224, v236
    v_add_f32 v225, v225, v237
    v_add_f32 v226, v226, v238
    v_add_f32 v227, v227, v239
    s_waitcnt lgkmcnt(3)
    v_add_f32 v224, v224, v240
    v_add_f32 v225, v225, v241
    v_add_f32 v226, v226, v242
    v_add_f32 v227, v227, v243
    s_waitcnt lgkmcnt(2)
    v_add_f32 v224, v224, v244
    v_add_f32 v225, v225, v245
    v_add_f32 v226, v226, v246
    v_add_f32 v227, v227, v247
    s_waitcnt lgkmcnt(1)
    v_add_f32 v224, v224, v248
    v_add_f32 v225, v225, v249
    v_add_f32 v226, v226, v250
    v_add_f32 v227, v227, v251
    s_waitcnt lgkmcnt(0)
    v_add_f32 v224, v224, v252
    v_add_f32 v225, v225, v253
    v_add_f32 v226, v226, v254
    v_add_f32 v227, v227, v255
    v_mul_f32 v224, v224, v23
    v_mul_f32 v225, v225, v23
    v_mul_f32 v226, v226, v23
    v_mul_f32 v227, v227, v23
    v_cvt_pk_bf16_f32 v228, v224, v225
    v_cvt_pk_bf16_f32 v229, v226, v227
    v_lshlrev_b32 v224, 16, v228
    v_and_b32 v225, 0xffff0000, v228
    v_lshlrev_b32 v226, 16, v229
    v_and_b32 v227, 0xffff0000, v229
    v_add_f32 v224, v224, v232
    v_add_f32 v225, v225, v233
    v_add_f32 v226, v226, v234
    v_add_f32 v227, v227, v235
    v_cvt_pk_bf16_f32 v230, v224, v225
    v_cvt_pk_bf16_f32 v231, v226, v227
    s_add_u32 s61, s61, 917504
    buffer_store_dwordx2 v[230:231], v19, s[36:39], s61 offen
L_fin:
L_end:
    s_endpgm
L_helper:
    s_cmp_ge_u32 s49, 8
    s_cbranch_scc1 L_end
    s_getpc_b64 s[62:63]
pc_43:
    s_sub_u32 s62, s62, pc_43-sequential_preLN__ssm_conv_h3__geglu_ffn__prompt_kernel
    s_subb_u32 s63, s63, 0
    s_lshl_b32 s57, s48, 6
    v_add_u32 v50, s57, v0
    v_lshlrev_b32 v50, 7, v50
    v_min_u32 v50, L_last-sequential_preLN__ssm_conv_h3__geglu_ffn__prompt_kernel, v50
    v_mov_b32 v51, s63
    v_add_co_u32 v50, vcc, s62, v50
    s_nop 1
    v_addc_co_u32 v51, vcc, 0, v51, vcc
    global_load_dword v52, v[50:51], off
    s_sub_u32 s51, s2, 224
    s_waitcnt lgkmcnt(0)
    s_mov_b64 s[4:5], s[64:65]
    s_mov_b32 s6, 1835008
    s_mov_b32 s7, 0x20000
    s_mov_b64 s[40:41], s[88:89]
    s_mov_b32 s42, 33554432
    s_mov_b32 s43, 0x20000
    s_mov_b64 s[20:21], s[72:73]
    s_mov_b32 s22, 1835008
    s_mov_b32 s23, 0x20000
    s_mov_b64 s[24:25], s[78:79]
    s_mov_b32 s26, 1605632
    s_mov_b32 s27, 0x20000
    s_mov_b64 s[28:29], s[80:81]
    s_mov_b32 s30, 1605632
    s_mov_b32 s31, 0x20000
    s_mov_b64 s[32:33], s[82:83]
    s_mov_b32 s34, 1605632
    s_mov_b32 s35, 0x20000
    s_mov_b64 s[36:37], s[84:85]
    s_mov_b32 s38, 1835008
    s_mov_b32 s39, 0x20000
    s_mov_b32 s46, 1605632
    s_mov_b32 s47, 0x20000
    s_bitcmp1_b32 s48, 0
    s_cselect_b64 s[44:45], s[80:81], s[78:79]
    s_mov_b32 s56, 1998848
    s_load_dword s3, s[88:89], s56
    s_lshl_b32 s56, s2, 3
    s_add_u32 s56, s56, s48
    s_mul_i32 s56, s56, 896
    v_lshlrev_b32 v92, 4, v0
    v_mov_b32 v88, 0
    v_mov_b32 v89, 0
    v_mov_b32 v90, 0
    v_mov_b32 v91, 0
    s_mov_b32 exec_hi, 0x00ffffff
    buffer_load_dwordx4 v[88:91], v92, s[4:7], s56 offen nt
    s_mov_b64 exec, -1
    s_and_b32 s94, s2, 7
    s_lshr_b32 s57, s2, 3
    s_lshr_b32 s92, s94, 2
    s_and_b32 s92, s57, 1
    s_bfe_u32 s90, s57, 0x10001
    s_and_b32 s56, s94, 6
    s_add_u32 s90, s90, s56
    s_and_b32 s56, s94, 1
    s_lshl3_add_u32 s90, s56, s90
    s_mov_b32 s93, 0
    s_mul_i32 s91, s92, 7
    s_add_u32 s91, s91, s93
    s_waitcnt lgkmcnt(0)
    s_mul_i32 s3, s3, 0x9E3779B1
    s_add_u32 s3, s3, 0x7F4A7C15
    s_waitcnt vmcnt(0)
    s_mov_b32 s56, 0x3f803f80
    v_dot2_f32_bf16 v92, v88, s56, 0
    v_dot2_f32_bf16 v93, v88, v88, 0
    v_dot2_f32_bf16 v92, v89, s56, v92
    v_dot2_f32_bf16 v93, v89, v89, v93
    v_dot2_f32_bf16 v92, v90, s56, v92
    v_dot2_f32_bf16 v93, v90, v90, v93
    v_dot2_f32_bf16 v92, v91, s56, v92
    v_dot2_f32_bf16 v93, v91, v91, v93
    s_lshr_b32 s56, s2, 6
    s_lshr_b32 s57, s48, 1
    s_lshl2_add_u32 s56, s56, s57
    v_permlane32_swap_b32 v92, v93
    v_add_f32 v92, v92, v93
    s_lshl_b32 s56, s56, 10
    s_and_b32 s57, s2, 63
    v_add_f32_dpp v92, v92, v92 row_ror:8 row_mask:0xf bank_mask:0xf
    s_lshl4_add_u32 s56, s57, s56
    s_and_b32 s57, s48, 1
    v_add_f32_dpp v92, v92, v92 row_ror:4 row_mask:0xf bank_mask:0xf
    s_lshl_b32 s57, s57, 3
    s_add_u32 s56, s56, s57
    v_add_f32_dpp v92, v92, v92 row_ror:2 row_mask:0xf bank_mask:0xf
    s_add_u32 s56, s56, 1835008
    s_nop 0
    v_add_f32_dpp v92, v92, v92 row_ror:1 row_mask:0xf bank_mask:0xf
    v_mov_b32 v93, v92
    s_nop 1
    v_permlane16_swap_b32 v92, v93
    v_add_f32 v92, v92, v93
    v_mov_b32 v93, v92
    s_nop 1
    v_permlane32_swap_b32 v92, v93
    v_mul_f32 v92, 0xbb124925, v92
    v_mul_f32 v93, 0x3b124925, v93
    v_fma_f32 v93, -v92, v92, v93
    v_max_f32 v93, 0, v93
    v_cvt_pk_bf16_f32 v93, v92, v93
    v_lshlrev_b32 v92, 16, v93
    v_and_b32 v93, 0xffff0000, v93
    v_add_f32 v93, 0x3727c5ac, v93
    v_cvt_pk_bf16_f32 v93, v93, v93
    v_lshlrev_b32 v93, 16, v93
    v_sqrt_f32 v93, v93
    s_nop 0
    v_cvt_pk_bf16_f32 v93, v93, v93
    v_lshlrev_b32 v93, 16, v93
    v_lshrrev_b32 v92, 16, v92
    v_or_b32 v92, v92, v93
    v_mov_b32 v93, s3
    s_mov_b64 exec, 1
    buffer_store_dwordx2 v[92:93], off, s[40:43], s56 sc1
    s_mov_b64 exec, -1
    s_waitcnt vmcnt(0)
    s_and_b32 s55, s51, 1
    s_bfe_u32 s56, s51, 0x20001
    s_lshr_b32 s51, s51, 3
    s_mov_b32 s84, s51
    s_mov_b32 s85, s56
    s_lshl2_add_u32 s51, s56, s51
    s_lshl4_add_u32 s51, s55, s51
    v_min_u32 v3, 55, v0
    v_mul_u32_u24 v4, 4682, v3
    v_lshrrev_b32 v4, 16, v4
    v_mul_u32_u24 v5, 14, v4
    v_sub_u32 v5, v3, v5
    s_movk_i32 s56, 3584
    v_lshlrev_b32 v6, 4, v5
    v_mad_u32_u24 v6, v4, s56, v6
    s_and_b32 s52, s51, 15
    s_mul_i32 s53, s52, 224
    s_mul_i32 s54, s48, 200704
    s_add_u32 s53, s53, s54
    s_cmp_ge_u32 s51, 16
    s_cselect_b64 s[44:45], s[28:29], s[24:25]
    s_add_u32 s54, s53, 0
    buffer_load_dwordx4 v[96:99], v6, s[44:47], s54 offen
    s_add_u32 s54, s53, 14336
    buffer_load_dwordx4 v[100:103], v6, s[44:47], s54 offen
    s_add_u32 s54, s53, 28672
    buffer_load_dwordx4 v[104:107], v6, s[44:47], s54 offen
    s_add_u32 s54, s53, 43008
    buffer_load_dwordx4 v[108:111], v6, s[44:47], s54 offen
    s_add_u32 s54, s53, 57344
    buffer_load_dwordx4 v[112:115], v6, s[44:47], s54 offen
    s_add_u32 s54, s53, 71680
    buffer_load_dwordx4 v[116:119], v6, s[44:47], s54 offen
    s_add_u32 s54, s53, 86016
    buffer_load_dwordx4 v[120:123], v6, s[44:47], s54 offen
    s_add_u32 s54, s53, 100352
    buffer_load_dwordx4 v[124:127], v6, s[44:47], s54 offen
    s_add_u32 s54, s53, 114688
    buffer_load_dwordx4 v[128:131], v6, s[44:47], s54 offen
    s_add_u32 s54, s53, 129024
    buffer_load_dwordx4 v[132:135], v6, s[44:47], s54 offen
    s_add_u32 s54, s53, 143360
    buffer_load_dwordx4 v[136:139], v6, s[44:47], s54 offen
    s_add_u32 s54, s53, 157696
    buffer_load_dwordx4 v[140:143], v6, s[44:47], s54 offen
    s_add_u32 s54, s53, 172032
    buffer_load_dwordx4 v[144:147], v6, s[44:47], s54 offen
    s_add_u32 s54, s53, 186368
    buffer_load_dwordx4 v[148:151], v6, s[44:47], s54 offen
    s_mov_b32 s62, 0x00003f80
    s_mov_b32 s63, 0x3f800000
    s_lshl_b32 s54, s48, 2
    v_add_u32 v4, s54, v4
    s_movk_i32 s56, 464
    v_lshlrev_b32 v5, 5, v5
    v_mad_u32_u24 v7, v4, s56, v5
    v_mov_b32 v84, 0
    v_mov_b32 v85, 0
    v_mov_b32 v86, 0
    v_mov_b32 v87, 0
    v_mov_b32 v88, 0
    v_mov_b32 v89, 0
    v_mov_b32 v90, 0
    v_mov_b32 v91, 0
    s_waitcnt vmcnt(13)
    v_dot2c_f32_bf16 v84, s62, v96
    v_dot2c_f32_bf16 v85, s63, v96
    v_dot2c_f32_bf16 v86, s62, v97
    v_dot2c_f32_bf16 v87, s63, v97
    v_dot2c_f32_bf16 v88, s62, v98
    v_dot2c_f32_bf16 v89, s63, v98
    v_dot2c_f32_bf16 v90, s62, v99
    v_dot2c_f32_bf16 v91, s63, v99
    s_waitcnt vmcnt(12)
    v_dot2c_f32_bf16 v84, s62, v100
    v_dot2c_f32_bf16 v85, s63, v100
    v_dot2c_f32_bf16 v86, s62, v101
    v_dot2c_f32_bf16 v87, s63, v101
    v_dot2c_f32_bf16 v88, s62, v102
    v_dot2c_f32_bf16 v89, s63, v102
    v_dot2c_f32_bf16 v90, s62, v103
    v_dot2c_f32_bf16 v91, s63, v103
    s_waitcnt vmcnt(11)
    v_dot2c_f32_bf16 v84, s62, v104
    v_dot2c_f32_bf16 v85, s63, v104
    v_dot2c_f32_bf16 v86, s62, v105
    v_dot2c_f32_bf16 v87, s63, v105
    v_dot2c_f32_bf16 v88, s62, v106
    v_dot2c_f32_bf16 v89, s63, v106
    v_dot2c_f32_bf16 v90, s62, v107
    v_dot2c_f32_bf16 v91, s63, v107
    s_waitcnt vmcnt(10)
    v_dot2c_f32_bf16 v84, s62, v108
    v_dot2c_f32_bf16 v85, s63, v108
    v_dot2c_f32_bf16 v86, s62, v109
    v_dot2c_f32_bf16 v87, s63, v109
    v_dot2c_f32_bf16 v88, s62, v110
    v_dot2c_f32_bf16 v89, s63, v110
    v_dot2c_f32_bf16 v90, s62, v111
    v_dot2c_f32_bf16 v91, s63, v111
    s_waitcnt vmcnt(9)
    v_dot2c_f32_bf16 v84, s62, v112
    v_dot2c_f32_bf16 v85, s63, v112
    v_dot2c_f32_bf16 v86, s62, v113
    v_dot2c_f32_bf16 v87, s63, v113
    v_dot2c_f32_bf16 v88, s62, v114
    v_dot2c_f32_bf16 v89, s63, v114
    v_dot2c_f32_bf16 v90, s62, v115
    v_dot2c_f32_bf16 v91, s63, v115
    s_waitcnt vmcnt(8)
    v_dot2c_f32_bf16 v84, s62, v116
    v_dot2c_f32_bf16 v85, s63, v116
    v_dot2c_f32_bf16 v86, s62, v117
    v_dot2c_f32_bf16 v87, s63, v117
    v_dot2c_f32_bf16 v88, s62, v118
    v_dot2c_f32_bf16 v89, s63, v118
    v_dot2c_f32_bf16 v90, s62, v119
    v_dot2c_f32_bf16 v91, s63, v119
    s_waitcnt vmcnt(7)
    v_dot2c_f32_bf16 v84, s62, v120
    v_dot2c_f32_bf16 v85, s63, v120
    v_dot2c_f32_bf16 v86, s62, v121
    v_dot2c_f32_bf16 v87, s63, v121
    v_dot2c_f32_bf16 v88, s62, v122
    v_dot2c_f32_bf16 v89, s63, v122
    v_dot2c_f32_bf16 v90, s62, v123
    v_dot2c_f32_bf16 v91, s63, v123
    s_waitcnt vmcnt(6)
    v_dot2c_f32_bf16 v84, s62, v124
    v_dot2c_f32_bf16 v85, s63, v124
    v_dot2c_f32_bf16 v86, s62, v125
    v_dot2c_f32_bf16 v87, s63, v125
    v_dot2c_f32_bf16 v88, s62, v126
    v_dot2c_f32_bf16 v89, s63, v126
    v_dot2c_f32_bf16 v90, s62, v127
    v_dot2c_f32_bf16 v91, s63, v127
    s_waitcnt vmcnt(5)
    v_dot2c_f32_bf16 v84, s62, v128
    v_dot2c_f32_bf16 v85, s63, v128
    v_dot2c_f32_bf16 v86, s62, v129
    v_dot2c_f32_bf16 v87, s63, v129
    v_dot2c_f32_bf16 v88, s62, v130
    v_dot2c_f32_bf16 v89, s63, v130
    v_dot2c_f32_bf16 v90, s62, v131
    v_dot2c_f32_bf16 v91, s63, v131
    s_waitcnt vmcnt(4)
    v_dot2c_f32_bf16 v84, s62, v132
    v_dot2c_f32_bf16 v85, s63, v132
    v_dot2c_f32_bf16 v86, s62, v133
    v_dot2c_f32_bf16 v87, s63, v133
    v_dot2c_f32_bf16 v88, s62, v134
    v_dot2c_f32_bf16 v89, s63, v134
    v_dot2c_f32_bf16 v90, s62, v135
    v_dot2c_f32_bf16 v91, s63, v135
    s_waitcnt vmcnt(3)
    v_dot2c_f32_bf16 v84, s62, v136
    v_dot2c_f32_bf16 v85, s63, v136
    v_dot2c_f32_bf16 v86, s62, v137
    v_dot2c_f32_bf16 v87, s63, v137
    v_dot2c_f32_bf16 v88, s62, v138
    v_dot2c_f32_bf16 v89, s63, v138
    v_dot2c_f32_bf16 v90, s62, v139
    v_dot2c_f32_bf16 v91, s63, v139
    s_waitcnt vmcnt(2)
    v_dot2c_f32_bf16 v84, s62, v140
    v_dot2c_f32_bf16 v85, s63, v140
    v_dot2c_f32_bf16 v86, s62, v141
    v_dot2c_f32_bf16 v87, s63, v141
    v_dot2c_f32_bf16 v88, s62, v142
    v_dot2c_f32_bf16 v89, s63, v142
    v_dot2c_f32_bf16 v90, s62, v143
    v_dot2c_f32_bf16 v91, s63, v143
    s_waitcnt vmcnt(1)
    v_dot2c_f32_bf16 v84, s62, v144
    v_dot2c_f32_bf16 v85, s63, v144
    v_dot2c_f32_bf16 v86, s62, v145
    v_dot2c_f32_bf16 v87, s63, v145
    v_dot2c_f32_bf16 v88, s62, v146
    v_dot2c_f32_bf16 v89, s63, v146
    v_dot2c_f32_bf16 v90, s62, v147
    v_dot2c_f32_bf16 v91, s63, v147
    s_waitcnt vmcnt(0)
    v_dot2c_f32_bf16 v84, s62, v148
    v_dot2c_f32_bf16 v85, s63, v148
    v_dot2c_f32_bf16 v86, s62, v149
    v_dot2c_f32_bf16 v87, s63, v149
    v_dot2c_f32_bf16 v88, s62, v150
    v_dot2c_f32_bf16 v89, s63, v150
    v_dot2c_f32_bf16 v90, s62, v151
    v_dot2c_f32_bf16 v91, s63, v151
    s_nop 2
    ds_write_b128 v7, v[84:87]
    ds_write_b128 v7, v[88:91] offset:16
    s_waitcnt lgkmcnt(0)
    s_barrier
    s_cmp_ge_u32 s48, 2
    s_cbranch_scc1 hc_44
    s_mul_i32 s54, s48, 56
    v_add_u32 v3, s54, v3
    v_lshlrev_b32 v4, 2, v3
    ds_read_b32 v96, v4 offset:0
    ds_read_b32 v97, v4 offset:464
    ds_read_b32 v98, v4 offset:928
    ds_read_b32 v99, v4 offset:1392
    ds_read_b32 v100, v4 offset:1856
    ds_read_b32 v101, v4 offset:2320
    ds_read_b32 v102, v4 offset:2784
    ds_read_b32 v103, v4 offset:3248
    ds_read_b32 v104, v4 offset:3712
    ds_read_b32 v105, v4 offset:4176
    ds_read_b32 v106, v4 offset:4640
    ds_read_b32 v107, v4 offset:5104
    ds_read_b32 v108, v4 offset:5568
    ds_read_b32 v109, v4 offset:6032
    ds_read_b32 v110, v4 offset:6496
    ds_read_b32 v111, v4 offset:6960
    ds_read_b32 v112, v4 offset:7424
    ds_read_b32 v113, v4 offset:7888
    ds_read_b32 v114, v4 offset:8352
    ds_read_b32 v115, v4 offset:8816
    ds_read_b32 v116, v4 offset:9280
    ds_read_b32 v117, v4 offset:9744
    ds_read_b32 v118, v4 offset:10208
    ds_read_b32 v119, v4 offset:10672
    ds_read_b32 v120, v4 offset:11136
    ds_read_b32 v121, v4 offset:11600
    ds_read_b32 v122, v4 offset:12064
    ds_read_b32 v123, v4 offset:12528
    ds_read_b32 v124, v4 offset:12992
    ds_read_b32 v125, v4 offset:13456
    ds_read_b32 v126, v4 offset:13920
    ds_read_b32 v127, v4 offset:14384
    s_mul_i32 s54, s52, 112
    v_add_u32 v3, s54, v3
    v_lshrrev_b32 v5, 4, v3
    v_and_b32 v3, 15, v3
    v_lshl_add_u32 v3, v5, 5, v3
    v_lshlrev_b32 v3, 4, v3
    s_and_b32 s54, s51, 16
    s_lshl_b32 s54, s54, 4
    s_add_u32 s54, s54, 2031616
    v_mov_b32 v87, 0
    s_waitcnt lgkmcnt(0)
    v_add_f32 v96, v96, v112
    v_add_f32 v97, v97, v113
    v_add_f32 v98, v98, v114
    v_add_f32 v99, v99, v115
    v_add_f32 v100, v100, v116
    v_add_f32 v101, v101, v117
    v_add_f32 v102, v102, v118
    v_add_f32 v103, v103, v119
    v_add_f32 v104, v104, v120
    v_add_f32 v105, v105, v121
    v_add_f32 v106, v106, v122
    v_add_f32 v107, v107, v123
    v_add_f32 v108, v108, v124
    v_add_f32 v109, v109, v125
    v_add_f32 v110, v110, v126
    v_add_f32 v111, v111, v127
    v_add_f32 v96, v96, v104
    v_add_f32 v97, v97, v105
    v_add_f32 v98, v98, v106
    v_add_f32 v99, v99, v107
    v_add_f32 v100, v100, v108
    v_add_f32 v101, v101, v109
    v_add_f32 v102, v102, v110
    v_add_f32 v103, v103, v111
    v_add_f32 v96, v96, v100
    v_add_f32 v97, v97, v101
    v_add_f32 v98, v98, v102
    v_add_f32 v99, v99, v103
    v_add_f32 v96, v96, v98
    v_add_f32 v97, v97, v99
    v_add_f32 v96, v96, v97
    v_cvt_pk_bf16_f32 v84, v96, 0
    v_lshlrev_b32 v97, 16, v84
    v_sub_f32 v96, v96, v97
    v_cvt_pk_bf16_f32 v85, v96, 0
    v_lshlrev_b32 v97, 16, v85
    v_sub_f32 v96, v96, v97
    v_cvt_pk_bf16_f32 v86, v96, 0
    buffer_store_dwordx4 v[84:87], v3, s[40:43], s54 offen sc1
hc_44:
    s_waitcnt vmcnt(0)
    s_barrier
    s_lshl4_add_u32 s51, s92, s90
    v_lshrrev_b32 v16, 3, v0
    v_bfe_u32 v17, v0, 4, 1
    v_lshlrev_b32 v17, 2, v17
    v_and_b32 v18, 7, v0
    v_xor_b32 v17, v17, v18
    v_lshlrev_b32 v17, 4, v17
    v_lshl_add_u32 v12, v16, 7, v17
    v_bfe_u32 v16, v0, 4, 1
    v_lshrrev_b32 v17, 5, v0
    v_bfe_u32 v18, v0, 2, 2
    v_and_b32 v19, 3, v0
    v_lshrrev_b32 v20, 1, v18
    v_lshlrev_b32 v21, 6, v20
    v_lshl_add_u32 v21, v16, 5, v21
    v_lshl_add_u32 v21, v19, 3, v21
    v_lshl_add_u32 v21, v18, 7, v21
    s_lshl_b32 s50, s48, 10
    v_lshl_add_u32 v13, v17, 9, v21
    v_add_u32 v13, s50, v13
    v_xor_b32 v14, 64, v13
    s_mul_i32 s52, s51, 57344
    s_add_u32 s52, s52, s50
    s_add_u32 s52, s52, 4194304
    s_mov_b32 s61, 0x3f803f80
    v_mul_u32_u24 v24, 48, v0
    v_add_u32 v24, 57344, v24
    s_lshl_b32 s58, s48, 2
    v_add_u32 v25, s58, v24
    v_mov_b32 v26, 0
    v_mov_b32 v27, 0
    v_mov_b32 v28, 0
    v_mov_b32 v29, 0
    s_cmp_lg_u32 s48, 0
    s_cbranch_scc1 h0_45
    s_lshl_b32 s60, s2, 5
    s_add_u32 s60, s60, 3932160
    s_add_u32 s59, s60, 65536
    v_mov_b32 v2, s3
    v_lshlrev_b32 v4, 13, v0
    s_mov_b64 exec, 0xff
    v_mov_b32 v3, s3
    buffer_store_dwordx2 v[2:3], v4, s[40:43], s60 offen sc1
    s_mov_b64 exec, -1
    v_mov_b32 v2, s3
    v_lshlrev_b32 v4, 13, v0
    s_mov_b64 exec, 0xff
    v_mov_b32 v3, s3
    buffer_store_dwordx2 v[2:3], v4, s[40:43], s59 offen sc1
    s_mov_b64 exec, -1
    s_and_b32 s56, s2, 7
    s_lshl3_add_u32 s60, s92, s56
    s_lshl_b32 s60, s60, 13
    s_add_u32 s60, s60, 3932160
    s_lshl_b32 s59, s56, 1
    s_add_u32 s59, s59, s92
    s_lshl_b32 s59, s59, 8
    s_add_u32 s59, s59, 1982464
    s_bitcmp1_b32 s2, 4
    s_cbranch_scc1 hw_46
    v_min_u32 v2, 255, v0
    v_lshlrev_b32 v4, 5, v2
    v_add_u32 v2, 64, v0
    v_min_u32 v2, 255, v2
    v_lshlrev_b32 v5, 5, v2
    v_add_u32 v2, 128, v0
    v_min_u32 v2, 255, v2
    v_lshlrev_b32 v6, 5, v2
    v_add_u32 v2, 192, v0
    v_min_u32 v2, 255, v2
    v_lshlrev_b32 v7, 5, v2
    buffer_load_dwordx2 v[64:65], v4, s[40:43], s60 offen sc1
    buffer_load_dwordx2 v[66:67], v5, s[40:43], s60 offen sc1
    buffer_load_dwordx2 v[68:69], v6, s[40:43], s60 offen sc1
    buffer_load_dwordx2 v[70:71], v7, s[40:43], s60 offen sc1
    s_mov_b32 s57, 0
poll_47:
    s_waitcnt vmcnt(0)
    v_cmp_ne_u32 s[64:65], s3, v64
    v_cmp_ne_u32 vcc, s3, v65
    s_or_b64 s[64:65], s[64:65], vcc
    v_cmp_ne_u32 s[66:67], s3, v66
    v_cmp_ne_u32 vcc, s3, v67
    s_or_b64 s[66:67], s[66:67], vcc
    v_cmp_ne_u32 s[68:69], s3, v68
    v_cmp_ne_u32 vcc, s3, v69
    s_or_b64 s[68:69], s[68:69], vcc
    v_cmp_ne_u32 s[70:71], s3, v70
    v_cmp_ne_u32 vcc, s3, v71
    s_or_b64 s[70:71], s[70:71], vcc
    s_or_b64 vcc, s[64:65], s[66:67]
    s_or_b64 vcc, vcc, s[68:69]
    s_or_b64 vcc, vcc, s[70:71]
    s_cmp_eq_u64 vcc, 0
    s_cbranch_scc1 pd_48
    s_add_u32 s57, s57, 1
    s_cmp_gt_u32 s57, 0x40000
    s_cbranch_scc1 pd_48
    s_mov_b64 exec, s[64:65]
    s_cbranch_execz ps_49
    buffer_load_dwordx2 v[64:65], v4, s[40:43], s60 offen sc1
ps_49:
    s_mov_b64 exec, s[66:67]
    s_cbranch_execz ps_50
    buffer_load_dwordx2 v[66:67], v5, s[40:43], s60 offen sc1
ps_50:
    s_mov_b64 exec, s[68:69]
    s_cbranch_execz ps_51
    buffer_load_dwordx2 v[68:69], v6, s[40:43], s60 offen sc1
ps_51:
    s_mov_b64 exec, s[70:71]
    s_cbranch_execz ps_52
    buffer_load_dwordx2 v[70:71], v7, s[40:43], s60 offen sc1
ps_52:
    s_mov_b64 exec, -1
    s_branch poll_47
pd_48:
    v_mov_b32 v2, s3
    s_mov_b64 exec, 1
    buffer_store_dword v2, off, s[40:43], s59 offset:128
    buffer_store_dword v2, off, s[40:43], s59 sc1
    s_mov_b64 exec, -1
    s_branch h0_45
hw_46:
    v_and_b32 v22, 1, v0
    v_lshlrev_b32 v22, 7, v22
    v_not_b32 v23, s3
    s_mov_b32 s57, 0
gw_53:
    v_cmp_eq_u32 vcc, s3, v23
    s_cbranch_vccnz gw_54
    s_add_u32 s57, s57, 1
    s_cmp_gt_u32 s57, 0x40000
    s_cbranch_scc1 gw_54
    s_sleep 1
    s_and_b32 s56, s57, 3
    s_cmp_eq_u32 s56, 0
    s_cselect_b32 exec_lo, 3, 2
    s_mov_b32 exec_hi, 0
    buffer_load_dword v23, v22, s[40:43], s59 offen sc1
    s_mov_b64 exec, -1
    s_waitcnt vmcnt(0)
    s_branch gw_53
gw_54:
h0_45:
    s_barrier
    s_add_u32 m0, s50, 0
    s_add_u32 s56, s52, 0
    buffer_load_dwordx4 v12, s[40:43], s56 offen sc1 lds
    s_add_u32 m0, s50, 8192
    s_add_u32 s56, s52, 8192
    buffer_load_dwordx4 v12, s[40:43], s56 offen sc1 lds
    s_add_u32 m0, s50, 16384
    s_add_u32 s56, s52, 16384
    buffer_load_dwordx4 v12, s[40:43], s56 offen sc1 lds
    s_add_u32 m0, s50, 24576
    s_add_u32 s56, s52, 24576
    buffer_load_dwordx4 v12, s[40:43], s56 offen sc1 lds
    s_add_u32 m0, s50, 32768
    s_add_u32 s56, s52, 32768
    buffer_load_dwordx4 v12, s[40:43], s56 offen sc1 lds
    s_add_u32 m0, s50, 40960
    s_add_u32 s56, s52, 40960
    buffer_load_dwordx4 v12, s[40:43], s56 offen sc1 lds
    s_add_u32 m0, s50, 49152
    s_add_u32 s56, s52, 49152
    buffer_load_dwordx4 v12, s[40:43], s56 offen sc1 lds
    s_waitcnt vmcnt(6)
    ds_read_b64_tr_b16 v[32:33], v13 offset:0
    ds_read_b64_tr_b16 v[34:35], v14 offset:0
    s_waitcnt vmcnt(5)
    ds_read_b64_tr_b16 v[36:37], v13 offset:8192
    ds_read_b64_tr_b16 v[38:39], v14 offset:8192
    s_waitcnt lgkmcnt(2)
    v_dot2c_f32_bf16 v26, s61, v32
    v_dot2c_f32_bf16 v27, v32, v32
    v_dot2c_f32_bf16 v26, s61, v33
    v_dot2c_f32_bf16 v27, v33, v33
    v_dot2c_f32_bf16 v28, s61, v34
    v_dot2c_f32_bf16 v29, v34, v34
    v_dot2c_f32_bf16 v28, s61, v35
    v_dot2c_f32_bf16 v29, v35, v35
    s_waitcnt vmcnt(4)
    ds_read_b64_tr_b16 v[40:41], v13 offset:16384
    ds_read_b64_tr_b16 v[42:43], v14 offset:16384
    s_waitcnt lgkmcnt(2)
    v_dot2c_f32_bf16 v26, s61, v36
    v_dot2c_f32_bf16 v27, v36, v36
    v_dot2c_f32_bf16 v26, s61, v37
    v_dot2c_f32_bf16 v27, v37, v37
    v_dot2c_f32_bf16 v28, s61, v38
    v_dot2c_f32_bf16 v29, v38, v38
    v_dot2c_f32_bf16 v28, s61, v39
    v_dot2c_f32_bf16 v29, v39, v39
    s_waitcnt vmcnt(3)
    ds_read_b64_tr_b16 v[44:45], v13 offset:24576
    ds_read_b64_tr_b16 v[46:47], v14 offset:24576
    s_waitcnt lgkmcnt(2)
    v_dot2c_f32_bf16 v26, s61, v40
    v_dot2c_f32_bf16 v27, v40, v40
    v_dot2c_f32_bf16 v26, s61, v41
    v_dot2c_f32_bf16 v27, v41, v41
    v_dot2c_f32_bf16 v28, s61, v42
    v_dot2c_f32_bf16 v29, v42, v42
    v_dot2c_f32_bf16 v28, s61, v43
    v_dot2c_f32_bf16 v29, v43, v43
    s_waitcnt vmcnt(2)
    ds_read_b64_tr_b16 v[48:49], v13 offset:32768
    ds_read_b64_tr_b16 v[50:51], v14 offset:32768
    s_waitcnt lgkmcnt(2)
    v_dot2c_f32_bf16 v26, s61, v44
    v_dot2c_f32_bf16 v27, v44, v44
    v_dot2c_f32_bf16 v26, s61, v45
    v_dot2c_f32_bf16 v27, v45, v45
    v_dot2c_f32_bf16 v28, s61, v46
    v_dot2c_f32_bf16 v29, v46, v46
    v_dot2c_f32_bf16 v28, s61, v47
    v_dot2c_f32_bf16 v29, v47, v47
    s_waitcnt vmcnt(1)
    ds_read_b64_tr_b16 v[52:53], v13 offset:40960
    ds_read_b64_tr_b16 v[54:55], v14 offset:40960
    s_waitcnt lgkmcnt(2)
    v_dot2c_f32_bf16 v26, s61, v48
    v_dot2c_f32_bf16 v27, v48, v48
    v_dot2c_f32_bf16 v26, s61, v49
    v_dot2c_f32_bf16 v27, v49, v49
    v_dot2c_f32_bf16 v28, s61, v50
    v_dot2c_f32_bf16 v29, v50, v50
    v_dot2c_f32_bf16 v28, s61, v51
    v_dot2c_f32_bf16 v29, v51, v51
    s_waitcnt vmcnt(0)
    ds_read_b64_tr_b16 v[56:57], v13 offset:49152
    ds_read_b64_tr_b16 v[58:59], v14 offset:49152
    s_waitcnt lgkmcnt(2)
    v_dot2c_f32_bf16 v26, s61, v52
    v_dot2c_f32_bf16 v27, v52, v52
    v_dot2c_f32_bf16 v26, s61, v53
    v_dot2c_f32_bf16 v27, v53, v53
    v_dot2c_f32_bf16 v28, s61, v54
    v_dot2c_f32_bf16 v29, v54, v54
    v_dot2c_f32_bf16 v28, s61, v55
    v_dot2c_f32_bf16 v29, v55, v55
    s_waitcnt lgkmcnt(0)
    v_dot2c_f32_bf16 v26, s61, v56
    v_dot2c_f32_bf16 v27, v56, v56
    v_dot2c_f32_bf16 v26, s61, v57
    v_dot2c_f32_bf16 v27, v57, v57
    v_dot2c_f32_bf16 v28, s61, v58
    v_dot2c_f32_bf16 v29, v58, v58
    v_dot2c_f32_bf16 v28, s61, v59
    v_dot2c_f32_bf16 v29, v59, v59
    s_nop 2
    v_permlane32_swap_b32 v26, v27
    v_permlane32_swap_b32 v28, v29
    v_add_f32 v26, v26, v27
    v_add_f32 v28, v28, v29
    ds_write_b32 v25, v26
    ds_write_b32 v25, v28 offset:3072
    s_waitcnt lgkmcnt(0)
    s_barrier
    s_cmp_ge_u32 s48, 2
    s_cbranch_scc1 he_55
    s_mul_i32 s56, s48, 3072
    v_add_u32 v24, s56, v24
    ds_read_b128 v[32:35], v24
    ds_read_b128 v[36:39], v24 offset:16
    s_lshl_b32 s56, s51, 1
    s_add_u32 s56, s56, s48
    s_lshl_b32 s56, s56, 8
    s_add_u32 s56, s56, 1851392
    v_lshlrev_b32 v2, 3, v0
    v_mov_b32 v31, s3
    s_waitcnt lgkmcnt(0)
    v_pk_add_f32 v[32:33], v[32:33], v[34:35]
    v_pk_add_f32 v[36:37], v[36:37], v[38:39]
    v_pk_add_f32 v[32:33], v[32:33], v[36:37]
    v_add_f32 v26, v32, v33
    v_add_f32 v27, v32, v33
    s_nop 1
    v_permlane32_swap_b32 v26, v27
    v_mul_f32 v26, 0xbb124925, v26
    v_mul_f32 v27, 0x3b124925, v27
    v_fma_f32 v27, -v26, v26, v27
    v_max_f32 v27, 0, v27
    v_cvt_pk_bf16_f32 v27, v26, v27
    v_lshlrev_b32 v26, 16, v27
    v_and_b32 v27, 0xffff0000, v27
    v_add_f32 v27, 0x3727c5ac, v27
    v_cvt_pk_bf16_f32 v27, v27, v27
    v_lshlrev_b32 v27, 16, v27
    v_sqrt_f32 v27, v27
    s_nop 0
    v_cvt_pk_bf16_f32 v27, v27, v27
    v_lshlrev_b32 v27, 16, v27
    v_lshrrev_b32 v26, 16, v26
    v_or_b32 v30, v26, v27
    s_mov_b32 exec_hi, 0
    buffer_store_dwordx2 v[30:31], v2, s[40:43], s56 offen sc1
    s_mov_b64 exec, -1
he_55:
L_last:
    s_branch L_fin
.section .rodata,"a"
.p2align 6
.amdhsa_kernel sequential_preLN__ssm_conv_h3__geglu_ffn__prompt_kernel
.amdhsa_next_free_vgpr 256
.amdhsa_next_free_sgpr 102
.amdhsa_accum_offset 256
.amdhsa_group_segment_fixed_size 0
.amdhsa_kernarg_size 104
.amdhsa_user_sgpr_count 2
.amdhsa_user_sgpr_kernarg_segment_ptr 1
.amdhsa_system_sgpr_workgroup_id_x 1
.end_amdhsa_kernel
```
